```python
import torch

def _softmax(x, axis=-1):
    return torch.softmax(x, dim=axis)

def _gelu(x):
    return torch.nn.functional.gelu(x, approximate='tanh')

def _silu(x):
    return torch.nn.functional.silu(x)

def _sigmoid(x):
    return torch.sigmoid(x)

def _layernorm(x, axis=-1, eps=1e-05):
    m = x.mean(dim=axis, keepdim=True)
    v = x.var(dim=axis, keepdim=True, unbiased=False)
    return (x - m) / torch.sqrt(v + eps)

def _scatter_add(tgt, idx, src, axis=0):
    return tgt.clone().index_add_(axis, idx, src)

def _segment_sum(src, seg, n):
    out = torch.zeros((n,) + src.shape[1:], dtype=src.dtype)
    return out.index_add_(0, seg, src)

def _pad(x, pw):
    flat = tuple((v for pair in reversed(pw) for v in pair))
    return torch.nn.functional.pad(x, flat)
kernel_name = 'adaLN_cond__mha_block_cached__geglu_ffn__decode'

def setup_inputs():

    _w = lambda a: (lambda t: t.to(torch.bfloat16) if t.is_floating_point() else t)(torch.as_tensor(a))

    def _A_setup():
        B, Sq, D = (1, 1, 512)
        H, Sk, Dh = (32, 65536, 128)
        return {'x': _w((lambda *s: torch.randn(*s, dtype=torch.bfloat16) * 0.1)(B, Sq, D)), 'k_cache': _w((lambda *s: torch.randn(*s, dtype=torch.bfloat16) * 0.8)(B, H, Sk, Dh)), 'v_cache': _w((lambda *s: torch.randn(*s, dtype=torch.bfloat16) * 1.6)(B, H, Sk, Dh)), 'wq': _w((lambda *s: torch.randn(*s, dtype=torch.bfloat16) * 0.8)(D, H * Dh) * D ** (-0.5)), 'wo': _w((lambda *s: torch.randn(*s, dtype=torch.bfloat16) * 1.6)(H * Dh, D) * (H * Dh) ** (-0.5))}
    _A_in = _A_setup()

    def _B_setup():
        B, S, D, F = (1, 1, 512, 1792)
        return {'x': _w((lambda *s: torch.randn(*s, dtype=torch.bfloat16) * 0.1)(B, S, D)), 'w_gate': _w((lambda *s: torch.randn(*s, dtype=torch.bfloat16) * 0.4)(D, F)), 'w_up': _w((lambda *s: torch.randn(*s, dtype=torch.bfloat16) * 0.4)(D, F)), 'w_down': _w((lambda *s: torch.randn(*s, dtype=torch.bfloat16) * 0.4)(F, D))}
    _B_in = _B_setup()
    return {'A_x': _A_in['x'], 'A_k_cache': _A_in['k_cache'], 'A_v_cache': _A_in['v_cache'], 'A_wq': _A_in['wq'], 'A_wo': _A_in['wo'], 'B_x': _B_in['x'], 'B_w_gate': _B_in['w_gate'], 'B_w_up': _B_in['w_up'], 'B_w_down': _B_in['w_down'], 'c': _w((lambda *s: torch.randn(*s, dtype=torch.bfloat16) * 0.4)(1, 512) * 8.0), 'w_mod': _w((lambda *s: torch.randn(*s, dtype=torch.bfloat16) * 0.4)(512, 6 * 512) * 512 ** (-0.5) * 8.0)}

def reference(A_x, A_k_cache, A_v_cache, A_wq, A_wo, B_x, B_w_gate, B_w_up, B_w_down, c, w_mod):

    def _A_ref(x, k_cache, v_cache, wq, wo):
        B, Sq, D = x.shape
        H, Dh = (32, 128)
        q = (lambda x, *d: x.permute(*d))((x @ wq).reshape(B, Sq, H, Dh), 0, 2, 1, 3)
        scores = torch.einsum('bhqd,bhkd->bhqk', q, k_cache) * Dh ** (-0.5)
        p = _softmax(scores, axis=-1)
        o = torch.einsum('bhqk,bhkd->bhqd', p, v_cache)
        return (lambda x, *d: x.permute(*d))(o, 0, 2, 1, 3).reshape(B, Sq, H * Dh) @ wo

    def _B_ref(x, w_gate, w_up, w_down):
        return _gelu(x @ w_gate) * (x @ w_up) @ w_down
    x = A_x
    mod = (_silu(c) @ w_mod).reshape(c.shape[0], 6, 1, -1)
    sa, ca, ga, sb, cb, gb = (mod[:, 0].clone(), mod[:, 1].clone(), mod[:, 2].clone(), mod[:, 3].clone(), mod[:, 4].clone(), mod[:, 5].clone())
    h = _layernorm(x, axis=-1) * (1 + ca) + sa
    x = x + ga * _A_ref(h, A_k_cache, A_v_cache, A_wq, A_wo)
    h = _layernorm(x, axis=-1) * (1 + cb) + sb
    x = x + gb * _B_ref(h, B_w_gate, B_w_up, B_w_down)
    return x
```

```asm
; @launch grid=(256,1,1) block=(320,1,1) lds=163840
.amdgcn_target "amdgcn-amd-amdhsa--gfx950"
.text
.globl adaLN_cond__mha_block_cached__geglu_ffn__decode_kernel
.p2align 8
.type adaLN_cond__mha_block_cached__geglu_ffn__decode_kernel,@function
adaLN_cond__mha_block_cached__geglu_ffn__decode_kernel:
    s_cmp_ge_u32 s2, 256
    s_cbranch_scc1 L_exit
    s_load_dwordx16 s[4:19], s[0:1], 0
    s_load_dwordx8 s[20:27], s[0:1], 64
    s_load_dwordx4 s[28:31], s[0:1], 96
    v_lshrrev_b32 v1, 6, v0
    v_and_b32 v0, 63, v0
    v_mov_b32 v4, 0
    v_readfirstlane_b32 s3, v1
    v_mov_b32 v5, 0
    v_mov_b32 v6, 0
    v_mov_b32 v7, 0
    v_mov_b32 v3, 0
    ds_write_b128 v3, v[4:7] offset:0
    ds_write_b128 v3, v[4:7] offset:32
    v_bfrev_b32 v5, -2
    ds_write_b128 v3, v[4:7] offset:16
    s_mov_b64 s[66:67], -1
    s_mov_b32 s59, 0x40000
    v_lshlrev_b32 v1, 4, v0
    s_lshr_b32 s91, s2, 3
    s_and_b32 s35, s2, 7
    s_cmp_lg_u32 s3, 0
    s_waitcnt lgkmcnt(0)
    s_cbranch_scc1 L_cons
    s_setprio 3
    s_lshl_b32 s48, s35, 21
    s_lshl_b32 s35, s91, 24
    s_mov_b32 s94, s35
    s_add_u32 s95, s94, 4096
    s_mov_b32 s96, s48
    s_add_u32 s40, s6, s94
    s_addc_u32 s41, s7, 0
    s_mov_b32 s42, 16777216
    s_mov_b32 s43, 0x20000
    s_add_u32 s44, s6, s95
    s_addc_u32 s45, s7, 0
    s_mov_b32 s46, 16773120
    s_mov_b32 s47, 0x20000
    s_mov_b32 s89, 244
    s_movk_i32 s88, 8192
    s_mov_b32 m0, 8192
    s_nop 0
    buffer_load_dwordx4 v1, s[40:43], s48 offen offset:0 nt lds
    buffer_load_dwordx4 v1, s[40:43], s48 offen offset:1024 nt lds
    buffer_load_dwordx4 v1, s[40:43], s48 offen offset:2048 nt lds
    buffer_load_dwordx4 v1, s[40:43], s48 offen offset:3072 nt lds
    s_add_u32 s48, s48, 4096
    s_mov_b32 m0, 12288
    s_nop 0
    buffer_load_dwordx4 v1, s[40:43], s48 offen offset:0 nt lds
    buffer_load_dwordx4 v1, s[40:43], s48 offen offset:1024 nt lds
    buffer_load_dwordx4 v1, s[40:43], s48 offen offset:2048 nt lds
    buffer_load_dwordx4 v1, s[40:43], s48 offen offset:3072 nt lds
    s_add_u32 s48, s48, 4096
    s_mov_b32 m0, 16384
    s_nop 0
    buffer_load_dwordx4 v1, s[40:43], s48 offen offset:0 nt lds
    buffer_load_dwordx4 v1, s[40:43], s48 offen offset:1024 nt lds
    buffer_load_dwordx4 v1, s[40:43], s48 offen offset:2048 nt lds
    buffer_load_dwordx4 v1, s[40:43], s48 offen offset:3072 nt lds
    s_add_u32 s48, s48, 4096
    s_mov_b32 m0, 20480
    s_nop 0
    buffer_load_dwordx4 v1, s[40:43], s48 offen offset:0 nt lds
    buffer_load_dwordx4 v1, s[40:43], s48 offen offset:1024 nt lds
    buffer_load_dwordx4 v1, s[40:43], s48 offen offset:2048 nt lds
    buffer_load_dwordx4 v1, s[40:43], s48 offen offset:3072 nt lds
    s_add_u32 s48, s48, 4096
    s_mov_b32 s49, 486
    s_mov_b32 s50, 24576
    s_mov_b32 s56, 2
    s_mov_b32 s57, 19
    v_mov_b32 v2, -1
    s_lshl_b32 s35, s91, 8
    s_add_u32 s35, s35, 32768
    s_add_u32 s36, s30, s35
    s_addc_u32 s37, s31, 0
    s_mov_b32 s38, 256
    s_mov_b32 s39, 0x20000
    s_barrier
L_ll:
    s_cmp_ge_u32 s56, s57
    s_cbranch_scc1 L_lstall
    s_mov_b32 m0, s50
    s_nop 0
    buffer_load_dwordx4 v1, s[40:43], s48 offen offset:0 nt lds
    ds_read_b128 v[4:7], v3 offset:32
    s_add_u32 s56, s56, 1
    s_waitcnt vmcnt(19)
    buffer_load_dwordx4 v1, s[40:43], s48 offen offset:1024 nt lds
    s_cmp_eq_u32 s49, 3
    s_cbranch_scc1 L_tk
L_tkr:
    s_waitcnt vmcnt(19)
    buffer_load_dwordx4 v1, s[40:43], s48 offen offset:2048 nt lds
    v_add_u32 v2, 1, v2
    s_waitcnt vmcnt(19)
    ds_write_b32 v3, v2 offset:16
    buffer_load_dwordx4 v1, s[40:43], s48 offen offset:3072 nt lds
    s_add_u32 m0, s50, 4096
    s_add_u32 s50, s50, 8192
    s_waitcnt vmcnt(19)
    buffer_load_dwordx4 v1, s[44:47], s48 offen offset:0 nt lds
    s_cmp_eq_u32 s50, 163840
    s_cselect_b32 s50, 24576, s50
    s_waitcnt vmcnt(19)
    buffer_load_dwordx4 v1, s[44:47], s48 offen offset:1024 nt lds
    s_waitcnt lgkmcnt(0)
    v_min3_u32 v4, v4, v5, v6
    v_min_u32 v4, v4, v7
    s_waitcnt vmcnt(19)
    buffer_load_dwordx4 v1, s[44:47], s48 offen offset:2048 nt lds
    v_readfirstlane_b32 s57, v4
    s_add_u32 s57, s57, 17
    s_max_u32 s57, s57, 19
    s_waitcnt vmcnt(19)
    buffer_load_dwordx4 v1, s[44:47], s48 offen offset:3072 nt lds
    s_add_u32 s48, s48, s88
    s_sub_u32 s49, s49, 1
    s_cmp_lg_u32 s49, s89
    s_waitcnt vmcnt(19)
    s_cbranch_scc1 L_ll
    s_cmp_eq_u32 s89, 0
    s_cbranch_scc1 L_tick
    s_add_u32 s40, s8, s94
    s_addc_u32 s41, s9, 0
    s_mov_b32 s42, 16777216
    s_mov_b32 s43, 0x20000
    s_add_u32 s44, s8, s95
    s_addc_u32 s45, s9, 0
    s_mov_b32 s46, 16773120
    s_mov_b32 s47, 0x20000
    s_mov_b32 s89, 0
    s_mov_b32 s48, s96
    s_branch L_ll
L_tick:
    s_add_u32 s40, s6, s94
    s_addc_u32 s41, s7, 0
    s_mov_b32 s42, 16777216
    s_mov_b32 s43, 0x20000
    s_add_u32 s44, s8, s94
    s_addc_u32 s45, s9, 0
    s_mov_b32 s46, 16777216
    s_mov_b32 s47, 0x20000
    s_movk_i32 s88, 4096
    v_readfirstlane_b32 s48, v8
    s_cmp_ge_u32 s48, 64
    s_cbranch_scc1 L_ldone
    s_mov_b32 s97, s48
    s_and_b32 s35, s48, 7
    s_lshr_b32 s48, s48, 3
    s_mul_i32 s48, s48, 12288
    s_lshl_b32 s35, s35, 21
    s_add_u32 s48, s48, 1998848
    s_add_u32 s48, s48, s35
    s_mov_b32 s49, 3
    s_cmp_lt_u32 s97, 48
    s_cbranch_scc1 L_ll
    s_add_u32 s35, s56, 3
    s_cmp_gt_u32 s35, s57
    s_cbranch_scc1 L_ll
    v_mov_b32 v8, 1
    s_mov_b64 exec, 1
    buffer_atomic_add v8, off, s[36:39], 0 sc0 sc1
    s_mov_b64 exec, -1
    s_mov_b32 s56, s35
    v_add_u32 v2, 3, v2
    s_add_u32 m0, s50, 0
    s_nop 0
    buffer_load_dwordx4 v1, s[40:43], s48 offen offset:0 nt lds
    buffer_load_dwordx4 v1, s[40:43], s48 offen offset:1024 nt lds
    buffer_load_dwordx4 v1, s[40:43], s48 offen offset:2048 nt lds
    buffer_load_dwordx4 v1, s[40:43], s48 offen offset:3072 nt lds
    s_add_u32 m0, s50, 4096
    s_nop 0
    buffer_load_dwordx4 v1, s[44:47], s48 offen offset:0 nt lds
    buffer_load_dwordx4 v1, s[44:47], s48 offen offset:1024 nt lds
    buffer_load_dwordx4 v1, s[44:47], s48 offen offset:2048 nt lds
    buffer_load_dwordx4 v1, s[44:47], s48 offen offset:3072 nt lds
    s_add_u32 s50, s50, 8192
    s_add_u32 s48, s48, 4096
    s_cmp_eq_u32 s50, 163840
    s_cselect_b32 s50, 24576, s50
    s_add_u32 m0, s50, 0
    s_nop 0
    buffer_load_dwordx4 v1, s[40:43], s48 offen offset:0 nt lds
    buffer_load_dwordx4 v1, s[40:43], s48 offen offset:1024 nt lds
    buffer_load_dwordx4 v1, s[40:43], s48 offen offset:2048 nt lds
    buffer_load_dwordx4 v1, s[40:43], s48 offen offset:3072 nt lds
    s_add_u32 m0, s50, 4096
    s_nop 0
    buffer_load_dwordx4 v1, s[44:47], s48 offen offset:0 nt lds
    buffer_load_dwordx4 v1, s[44:47], s48 offen offset:1024 nt lds
    buffer_load_dwordx4 v1, s[44:47], s48 offen offset:2048 nt lds
    buffer_load_dwordx4 v1, s[44:47], s48 offen offset:3072 nt lds
    s_add_u32 s50, s50, 8192
    s_add_u32 s48, s48, 4096
    s_cmp_eq_u32 s50, 163840
    s_cselect_b32 s50, 24576, s50
    s_add_u32 m0, s50, 0
    s_nop 0
    buffer_load_dwordx4 v1, s[40:43], s48 offen offset:0 nt lds
    buffer_load_dwordx4 v1, s[40:43], s48 offen offset:1024 nt lds
    buffer_load_dwordx4 v1, s[40:43], s48 offen offset:2048 nt lds
    buffer_load_dwordx4 v1, s[40:43], s48 offen offset:3072 nt lds
    s_add_u32 m0, s50, 4096
    s_nop 0
    buffer_load_dwordx4 v1, s[44:47], s48 offen offset:0 nt lds
    buffer_load_dwordx4 v1, s[44:47], s48 offen offset:1024 nt lds
    buffer_load_dwordx4 v1, s[44:47], s48 offen offset:2048 nt lds
    buffer_load_dwordx4 v1, s[44:47], s48 offen offset:3072 nt lds
    s_add_u32 s50, s50, 8192
    s_add_u32 s48, s48, 4096
    s_cmp_eq_u32 s50, 163840
    s_cselect_b32 s50, 24576, s50
    v_mov_b32 v9, s56
    v_subrev_u32 v10, 5, v9
    s_waitcnt vmcnt(40)
    ds_write_b32 v3, v10 offset:16
    v_subrev_u32 v10, 4, v9
    s_waitcnt vmcnt(32)
    ds_write_b32 v3, v10 offset:16
    v_subrev_u32 v10, 3, v9
    s_waitcnt vmcnt(24)
    ds_write_b32 v3, v10 offset:16
    ds_read_b128 v[4:7], v3 offset:32
    s_waitcnt lgkmcnt(0)
    v_min3_u32 v4, v4, v5, v6
    v_min_u32 v4, v4, v7
    s_nop 0
    v_readfirstlane_b32 s57, v4
    s_add_u32 s57, s57, 17
    s_branch L_tick
L_tk:
    v_mov_b32 v8, 1
    s_mov_b64 exec, 1
    buffer_atomic_add v8, off, s[36:39], 0 sc0 sc1
    s_mov_b64 exec, -1
    s_branch L_tkr
L_ldone:
    v_mov_b32 v5, s56
    v_subrev_u32 v4, 2, v5
    s_waitcnt vmcnt(16)
    ds_write_b64 v3, v[4:5] offset:16
    v_subrev_u32 v4, 1, v5
    s_waitcnt vmcnt(8)
    ds_write_b64 v3, v[4:5] offset:16
    v_subrev_u32 v4, 0, v5
    s_waitcnt vmcnt(0)
    ds_write_b64 v3, v[4:5] offset:16
    s_waitcnt lgkmcnt(0)
    s_setprio 0
    s_and_b32 s35, s2, 7
    s_mov_b32 s3, 1
    s_sub_u32 s33, s3, 1
    s_lshr_b32 s48, s91, 1
    s_add_u32 s69, s35, s48
    s_and_b32 s69, s69, 7
    s_lshl_b32 s48, s48, 2
    s_add_u32 s48, s48, s69
    s_lshl_b32 s48, s48, 1
    s_and_b32 s35, s91, 1
    s_or_b32 s34, s48, s35
    s_sub_u32 s48, s69, 4
    s_lshl_b32 s48, s48, 5
    s_add_u32 s48, s48, s91
    s_cmp_ge_u32 s69, 4
    s_cselect_b32 s34, s48, s34
    s_sub_u32 s68, 7, s69
    s_lshl_b32 s68, s68, 5
    s_add_u32 s68, s68, s91
    s_mov_b32 s53, 0x05040100
    s_mov_b32 s54, 0x07060302
    s_mov_b32 s51, 0x3fb8aa3b
    s_mov_b32 s55, 0xbfb8aa3b
    s_mov_b32 s52, 0xffff0000
    s_mov_b32 s58, 0x3db504f3
    s_mov_b32 s60, s26
    s_mov_b32 s61, s27
    s_mov_b32 s62, 1024
    s_mov_b32 s63, 0x20000
    v_mov_b32 v24, 0
    v_mov_b32 v25, 0
    v_mov_b32 v26, 0
    v_mov_b32 v28, 0
    v_mov_b32 v30, 0
    v_mov_b32 v31, 0
    v_mov_b32 v66, 0
    v_mov_b32 v67, 0
    v_mov_b32 v68, 0
    v_mov_b32 v69, 0
    v_mov_b32 v110, 0
    v_mov_b32 v111, 0
    v_mov_b32 v112, 0
    v_mov_b32 v113, 0
    v_mov_b32 v114, 0
    v_mov_b32 v115, 0
    v_mov_b32 v116, 0
    v_mov_b32 v120, 0
    v_mov_b32 v122, 0
    s_mov_b32 s49, 0
    s_mov_b32 s3, 0
    s_mov_b32 s90, 0
    s_mov_b32 s32, 0
    s_mov_b64 s[64:65], 0
    s_mov_b64 s[66:67], 0
    s_mov_b64 exec, 0
    s_branch L_notlast
L_lstall:
    ds_read_b128 v[4:7], v3 offset:32
    s_sub_u32 s59, s59, 1
    s_cbranch_scc1 L_end
    s_waitcnt lgkmcnt(0)
    v_min3_u32 v4, v4, v5, v6
    v_min_u32 v4, v4, v7
    s_nop 0
    v_readfirstlane_b32 s57, v4
    s_add_u32 s57, s57, 17
    s_max_u32 s57, s57, 19
    s_branch L_ll
L_cons:
    s_mov_b32 s36, s30
    s_mov_b32 s37, s31
    s_mov_b32 s38, 458752
    s_mov_b32 s39, 0x20000
    buffer_load_dword v64, off, s[36:39], 0 sc1
    s_sub_u32 s33, s3, 1
    s_lshr_b32 s48, s91, 1
    s_add_u32 s69, s35, s48
    s_and_b32 s69, s69, 7
    s_lshl_b32 s48, s48, 2
    s_add_u32 s48, s48, s69
    s_lshl_b32 s48, s48, 1
    s_and_b32 s35, s91, 1
    s_or_b32 s34, s48, s35
    s_sub_u32 s48, s69, 4
    s_lshl_b32 s48, s48, 5
    s_add_u32 s48, s48, s91
    s_cmp_ge_u32 s69, 4
    s_cselect_b32 s34, s48, s34
    s_sub_u32 s68, 7, s69
    s_lshl_b32 s68, s68, 5
    s_add_u32 s68, s68, s91
    s_mov_b32 s53, 0x05040100
    s_mov_b32 s54, 0x07060302
    s_mov_b32 s51, 0x3fb8aa3b
    s_mov_b32 s55, 0xbfb8aa3b
    s_mov_b32 s52, 0xffff0000
    s_mov_b32 s58, 0x3db504f3
    s_setprio 1
    v_lshrrev_b32 v65, 2, v0
    v_lshlrev_b32 v65, 3, v65
    s_lshl_b32 s35, s33, 7
    v_add_u32 v65, s35, v65
    v_and_b32 v66, 3, v0
    v_lshlrev_b32 v66, 4, v66
    v_lshrrev_b32 v67, 4, v0
    v_lshlrev_b32 v67, 3, v67
    v_lshl_add_u32 v67, v66, 1, v67
    v_add_u32 v67, s35, v67
    v_lshlrev_b32 v68, 2, v65
    v_lshlrev_b32 v69, 1, v65
    s_lshl_b32 s49, s34, 6
    s_cmp_lt_u32 s69, 4
    s_cbranch_scc1 L_qstage
    s_cmp_eq_u32 s69, 7
    s_cbranch_scc1 L_idle
    s_cmp_lg_u32 s69, 4
    s_cbranch_scc1 L_noclr
    v_mov_b32 v24, -1
    v_mov_b32 v25, -1
    v_mov_b32 v26, -1
    v_mov_b32 v27, -1
    s_lshl_b32 s35, s91, 2
    s_add_u32 s35, s35, s33
    s_mul_i32 s50, s35, 1024
    s_add_u32 s50, s50, 327680
    buffer_store_dwordx4 v[24:27], v1, s[36:39], s50 offen sc1
    s_lshl_b32 s48, s35, 11
    s_add_u32 s48, s48, 65536
    s_mov_b32 exec_hi, 15
    buffer_store_dwordx4 v[24:27], v1, s[36:39], s48 offen sc1
    buffer_store_dwordx4 v[24:27], v1, s[36:39], s48 offen offset:1024 sc1
    s_lshl_b32 s48, s35, 6
    s_add_u32 s48, s48, 32768
    s_mov_b64 exec, 1
    buffer_store_dword v3, off, s[36:39], s48 sc1
    s_mov_b64 exec, -1
L_noclr:
    global_load_dwordx4 v[72:75], v69, s[22:23]
    s_mov_b32 s40, s24
    s_mov_b32 s41, s25
    s_mov_b32 s42, 3145728
    s_mov_b32 s43, 0x20000
    s_movk_i32 s35, 6144
    v_mul_lo_u32 v70, s35, v65
    v_add3_u32 v70, v70, v66, s49
    buffer_load_dwordx4 v[128:131], v70, s[40:43], 0 offen nt
    s_mov_b32 s48, 6144
    buffer_load_dwordx4 v[132:135], v70, s[40:43], s48 offen nt
    s_mov_b32 s48, 12288
    buffer_load_dwordx4 v[136:139], v70, s[40:43], s48 offen nt
    s_mov_b32 s48, 18432
    buffer_load_dwordx4 v[140:143], v70, s[40:43], s48 offen nt
    s_mov_b32 s48, 24576
    buffer_load_dwordx4 v[144:147], v70, s[40:43], s48 offen nt
    s_mov_b32 s48, 30720
    buffer_load_dwordx4 v[148:151], v70, s[40:43], s48 offen nt
    s_mov_b32 s48, 36864
    buffer_load_dwordx4 v[152:155], v70, s[40:43], s48 offen nt
    s_mov_b32 s48, 43008
    buffer_load_dwordx4 v[156:159], v70, s[40:43], s48 offen nt
    s_barrier
    s_waitcnt vmcnt(8)
    v_and_b32 v77, s52, v72
    v_lshlrev_b32 v76, 16, v72
    v_and_b32 v79, s52, v73
    v_lshlrev_b32 v78, 16, v73
    v_and_b32 v81, s52, v74
    v_lshlrev_b32 v80, 16, v74
    v_and_b32 v83, s52, v75
    v_lshlrev_b32 v82, 16, v75
    s_mov_b32 s35, 0xb2a57060
    v_mul_f32 v84, s55, v76
    v_mul_f32 v85, s55, v77
    v_mul_f32 v86, s55, v78
    v_mul_f32 v87, s55, v79
    v_mul_f32 v88, s55, v80
    v_mul_f32 v89, s55, v81
    v_mul_f32 v90, s55, v82
    v_mul_f32 v91, s55, v83
    v_fma_f32 v92, v76, s55, -v84
    v_fma_f32 v93, v77, s55, -v85
    v_fma_f32 v94, v78, s55, -v86
    v_fma_f32 v95, v79, s55, -v87
    v_fma_f32 v96, v80, s55, -v88
    v_fma_f32 v97, v81, s55, -v89
    v_fma_f32 v98, v82, s55, -v90
    v_fma_f32 v99, v83, s55, -v91
    v_exp_f32 v84, v84
    v_exp_f32 v85, v85
    v_exp_f32 v86, v86
    v_exp_f32 v87, v87
    v_exp_f32 v88, v88
    v_exp_f32 v89, v89
    v_exp_f32 v90, v90
    v_exp_f32 v91, v91
    v_fmac_f32 v92, s35, v76
    v_fmac_f32 v93, s35, v77
    v_fmac_f32 v94, s35, v78
    v_fmac_f32 v95, s35, v79
    v_fmac_f32 v96, s35, v80
    v_fmac_f32 v97, s35, v81
    v_fmac_f32 v98, s35, v82
    v_fmac_f32 v99, s35, v83
    v_min_f32 v84, 0x7e000000, v84
    v_min_f32 v85, 0x7e000000, v85
    v_min_f32 v86, 0x7e000000, v86
    v_min_f32 v87, 0x7e000000, v87
    v_min_f32 v88, 0x7e000000, v88
    v_min_f32 v89, 0x7e000000, v89
    v_min_f32 v90, 0x7e000000, v90
    v_min_f32 v91, 0x7e000000, v91
    v_mul_f32 v92, 0x3f317218, v92
    v_mul_f32 v93, 0x3f317218, v93
    v_mul_f32 v94, 0x3f317218, v94
    v_mul_f32 v95, 0x3f317218, v95
    v_mul_f32 v96, 0x3f317218, v96
    v_mul_f32 v97, 0x3f317218, v97
    v_mul_f32 v98, 0x3f317218, v98
    v_mul_f32 v99, 0x3f317218, v99
    v_fmac_f32 v84, v92, v84
    v_fmac_f32 v85, v93, v85
    v_fmac_f32 v86, v94, v86
    v_fmac_f32 v87, v95, v87
    v_fmac_f32 v88, v96, v88
    v_fmac_f32 v89, v97, v89
    v_fmac_f32 v90, v98, v90
    v_fmac_f32 v91, v99, v91
    v_add_f32 v84, 1.0, v84
    v_add_f32 v85, 1.0, v85
    v_add_f32 v86, 1.0, v86
    v_add_f32 v87, 1.0, v87
    v_add_f32 v88, 1.0, v88
    v_add_f32 v89, 1.0, v89
    v_add_f32 v90, 1.0, v90
    v_add_f32 v91, 1.0, v91
    v_rcp_f32 v92, v84
    v_rcp_f32 v93, v85
    v_rcp_f32 v94, v86
    v_rcp_f32 v95, v87
    v_rcp_f32 v96, v88
    v_rcp_f32 v97, v89
    v_rcp_f32 v98, v90
    v_rcp_f32 v99, v91
    v_mul_f32 v100, v76, v92
    v_mul_f32 v101, v77, v93
    v_mul_f32 v102, v78, v94
    v_mul_f32 v103, v79, v95
    v_mul_f32 v104, v80, v96
    v_mul_f32 v105, v81, v97
    v_mul_f32 v106, v82, v98
    v_mul_f32 v107, v83, v99
    v_fma_f32 v84, -v100, v84, v76
    v_fma_f32 v85, -v101, v85, v77
    v_fma_f32 v86, -v102, v86, v78
    v_fma_f32 v87, -v103, v87, v79
    v_fma_f32 v88, -v104, v88, v80
    v_fma_f32 v89, -v105, v89, v81
    v_fma_f32 v90, -v106, v90, v82
    v_fma_f32 v91, -v107, v91, v83
    v_fma_f32 v84, v84, v92, v100
    v_fma_f32 v85, v85, v93, v101
    v_fma_f32 v86, v86, v94, v102
    v_fma_f32 v87, v87, v95, v103
    v_fma_f32 v88, v88, v96, v104
    v_fma_f32 v89, v89, v97, v105
    v_fma_f32 v90, v90, v98, v106
    v_fma_f32 v91, v91, v99, v107
    v_cvt_pk_bf16_f32 v72, v84, v85
    v_cvt_pk_bf16_f32 v73, v86, v87
    v_cvt_pk_bf16_f32 v74, v88, v89
    v_cvt_pk_bf16_f32 v75, v90, v91
    v_readfirstlane_b32 s32, v64
    s_add_u32 s32, s32, 0x9e3779b9
    s_mov_b32 s50, 4096
    s_waitcnt vmcnt(0)
    v_perm_b32 v127, v132, v128, s53
    v_perm_b32 v132, v132, v128, s54
    v_perm_b32 v128, v133, v129, s53
    v_perm_b32 v133, v133, v129, s54
    v_perm_b32 v129, v134, v130, s53
    v_perm_b32 v134, v134, v130, s54
    v_perm_b32 v130, v135, v131, s53
    v_perm_b32 v135, v135, v131, s54
    v_perm_b32 v131, v140, v136, s53
    v_perm_b32 v140, v140, v136, s54
    v_perm_b32 v136, v141, v137, s53
    v_perm_b32 v141, v141, v137, s54
    v_perm_b32 v137, v142, v138, s53
    v_perm_b32 v142, v142, v138, s54
    v_perm_b32 v138, v143, v139, s53
    v_perm_b32 v143, v143, v139, s54
    v_perm_b32 v139, v148, v144, s53
    v_perm_b32 v148, v148, v144, s54
    v_perm_b32 v144, v149, v145, s53
    v_perm_b32 v149, v149, v145, s54
    v_perm_b32 v145, v150, v146, s53
    v_perm_b32 v150, v150, v146, s54
    v_perm_b32 v146, v151, v147, s53
    v_perm_b32 v151, v151, v147, s54
    v_perm_b32 v147, v156, v152, s53
    v_perm_b32 v156, v156, v152, s54
    v_perm_b32 v152, v157, v153, s53
    v_perm_b32 v157, v157, v153, s54
    v_perm_b32 v153, v158, v154, s53
    v_perm_b32 v158, v158, v154, s54
    v_perm_b32 v154, v159, v155, s53
    v_perm_b32 v159, v159, v155, s54
    s_branch L_pgemv
L_qstage:
    global_load_dwordx4 v[72:75], v69, s[4:5]
    global_load_dwordx4 v[92:95], v1, s[4:5]
    s_mov_b32 s40, s10
    s_mov_b32 s41, s11
    s_mov_b32 s42, 4194304
    s_mov_b32 s43, 0x20000
    v_lshlrev_b32 v70, 13, v65
    v_add3_u32 v70, v70, v66, s49
    buffer_load_dwordx4 v[128:131], v70, s[40:43], 0 offen nt
    s_mov_b32 s48, 8192
    buffer_load_dwordx4 v[132:135], v70, s[40:43], s48 offen nt
    s_mov_b32 s48, 16384
    buffer_load_dwordx4 v[136:139], v70, s[40:43], s48 offen nt
    s_mov_b32 s48, 24576
    buffer_load_dwordx4 v[140:143], v70, s[40:43], s48 offen nt
    s_mov_b32 s48, 32768
    buffer_load_dwordx4 v[144:147], v70, s[40:43], s48 offen nt
    s_mov_b32 s48, 40960
    buffer_load_dwordx4 v[148:151], v70, s[40:43], s48 offen nt
    s_mov_b32 s48, 49152
    buffer_load_dwordx4 v[152:155], v70, s[40:43], s48 offen nt
    s_mov_b32 s48, 57344
    buffer_load_dwordx4 v[156:159], v70, s[40:43], s48 offen nt
    s_barrier
    s_waitcnt vmcnt(8)
    v_and_b32 v97, s52, v92
    v_lshlrev_b32 v96, 16, v92
    v_and_b32 v99, s52, v93
    v_lshlrev_b32 v98, 16, v93
    v_and_b32 v101, s52, v94
    v_lshlrev_b32 v100, 16, v94
    v_and_b32 v103, s52, v95
    v_lshlrev_b32 v102, 16, v95
    v_pk_add_f32 v[106:107], v[96:97], v[98:99]
    v_pk_add_f32 v[104:105], v[100:101], v[102:103]
    v_pk_add_f32 v[106:107], v[106:107], v[104:105]
    v_add_f32 v106, v106, v107
    s_nop 1
    v_add_f32_dpp v106, v106, v106 row_ror:8 row_mask:0xf bank_mask:0xf
    s_nop 1
    v_add_f32_dpp v106, v106, v106 row_ror:4 row_mask:0xf bank_mask:0xf
    s_nop 1
    v_add_f32_dpp v106, v106, v106 row_ror:2 row_mask:0xf bank_mask:0xf
    s_nop 1
    v_add_f32_dpp v106, v106, v106 row_ror:1 row_mask:0xf bank_mask:0xf
    v_mov_b32 v104, v106
    s_nop 1
    v_permlane32_swap_b32 v106, v104
    v_add_f32 v106, v106, v104
    v_mov_b32 v104, v106
    s_nop 1
    v_permlane16_swap_b32 v106, v104
    v_add_f32 v106, v106, v104
    v_mul_f32 v106, 0x3b000000, v106
    v_pk_add_f32 v[96:97], v[96:97], v[106:107] op_sel_hi:[1,0] neg_lo:[0,1] neg_hi:[0,1]
    v_pk_add_f32 v[98:99], v[98:99], v[106:107] op_sel_hi:[1,0] neg_lo:[0,1] neg_hi:[0,1]
    v_pk_add_f32 v[100:101], v[100:101], v[106:107] op_sel_hi:[1,0] neg_lo:[0,1] neg_hi:[0,1]
    v_pk_add_f32 v[102:103], v[102:103], v[106:107] op_sel_hi:[1,0] neg_lo:[0,1] neg_hi:[0,1]
    v_pk_mul_f32 v[96:97], v[96:97], v[96:97]
    v_pk_fma_f32 v[96:97], v[98:99], v[98:99], v[96:97]
    v_pk_fma_f32 v[96:97], v[100:101], v[100:101], v[96:97]
    v_pk_fma_f32 v[96:97], v[102:103], v[102:103], v[96:97]
    v_add_f32 v107, v96, v97
    s_nop 1
    v_add_f32_dpp v107, v107, v107 row_ror:8 row_mask:0xf bank_mask:0xf
    s_nop 1
    v_add_f32_dpp v107, v107, v107 row_ror:4 row_mask:0xf bank_mask:0xf
    s_nop 1
    v_add_f32_dpp v107, v107, v107 row_ror:2 row_mask:0xf bank_mask:0xf
    s_nop 1
    v_add_f32_dpp v107, v107, v107 row_ror:1 row_mask:0xf bank_mask:0xf
    v_mov_b32 v104, v107
    s_nop 1
    v_permlane32_swap_b32 v107, v104
    v_add_f32 v107, v107, v104
    v_mov_b32 v104, v107
    s_nop 1
    v_permlane16_swap_b32 v107, v104
    v_add_f32 v107, v107, v104
    v_mul_f32 v107, 0x3b000000, v107
    v_cvt_pk_bf16_f32 v107, v106, v107
    v_lshlrev_b32 v106, 16, v107
    v_and_b32 v107, s52, v107
    v_add_f32 v107, 0x3727c5ac, v107
    v_cvt_pk_bf16_f32 v107, v107, v107
    v_lshlrev_b32 v107, 16, v107
    v_sqrt_f32 v107, v107
    s_nop 0
    v_cvt_pk_bf16_f32 v107, v107, v107
    v_lshlrev_b32 v107, 16, v107
    v_rcp_f32 v107, v107
    v_and_b32 v77, s52, v72
    v_lshlrev_b32 v76, 16, v72
    v_and_b32 v79, s52, v73
    v_lshlrev_b32 v78, 16, v73
    v_and_b32 v81, s52, v74
    v_lshlrev_b32 v80, 16, v74
    v_and_b32 v83, s52, v75
    v_lshlrev_b32 v82, 16, v75
    v_sub_f32 v76, v76, v106
    v_sub_f32 v77, v77, v106
    v_sub_f32 v78, v78, v106
    v_sub_f32 v79, v79, v106
    v_sub_f32 v80, v80, v106
    v_sub_f32 v81, v81, v106
    v_sub_f32 v82, v82, v106
    v_sub_f32 v83, v83, v106
    v_cvt_pk_bf16_f32 v77, v76, v77
    v_cvt_pk_bf16_f32 v79, v78, v79
    v_cvt_pk_bf16_f32 v81, v80, v81
    v_cvt_pk_bf16_f32 v83, v82, v83
    v_lshlrev_b32 v76, 16, v77
    v_and_b32 v77, s52, v77
    v_lshlrev_b32 v78, 16, v79
    v_and_b32 v79, s52, v79
    v_lshlrev_b32 v80, 16, v81
    v_and_b32 v81, s52, v81
    v_lshlrev_b32 v82, 16, v83
    v_and_b32 v83, s52, v83
    v_mul_f32 v76, v76, v107
    v_mul_f32 v77, v77, v107
    v_mul_f32 v78, v78, v107
    v_mul_f32 v79, v79, v107
    v_mul_f32 v80, v80, v107
    v_mul_f32 v81, v81, v107
    v_mul_f32 v82, v82, v107
    v_mul_f32 v83, v83, v107
    v_cvt_pk_bf16_f32 v77, v76, v77
    v_cvt_pk_bf16_f32 v79, v78, v79
    v_cvt_pk_bf16_f32 v81, v80, v81
    v_cvt_pk_bf16_f32 v83, v82, v83
    v_lshlrev_b32 v76, 16, v77
    v_and_b32 v77, s52, v77
    v_lshlrev_b32 v78, 16, v79
    v_and_b32 v79, s52, v79
    v_lshlrev_b32 v80, 16, v81
    v_and_b32 v81, s52, v81
    v_lshlrev_b32 v82, 16, v83
    v_and_b32 v83, s52, v83
    v_readfirstlane_b32 s32, v64
    s_add_u32 s32, s32, 0x9e3779b9
    s_mov_b32 s50, 16384
    s_waitcnt vmcnt(0)
    v_perm_b32 v127, v132, v128, s53
    v_perm_b32 v132, v132, v128, s54
    v_perm_b32 v128, v133, v129, s53
    v_perm_b32 v133, v133, v129, s54
    v_perm_b32 v129, v134, v130, s53
    v_perm_b32 v134, v134, v130, s54
    v_perm_b32 v130, v135, v131, s53
    v_perm_b32 v135, v135, v131, s54
    v_perm_b32 v131, v140, v136, s53
    v_perm_b32 v140, v140, v136, s54
    v_perm_b32 v136, v141, v137, s53
    v_perm_b32 v141, v141, v137, s54
    v_perm_b32 v137, v142, v138, s53
    v_perm_b32 v142, v142, v138, s54
    v_perm_b32 v138, v143, v139, s53
    v_perm_b32 v143, v143, v139, s54
    v_perm_b32 v139, v148, v144, s53
    v_perm_b32 v148, v148, v144, s54
    v_perm_b32 v144, v149, v145, s53
    v_perm_b32 v149, v149, v145, s54
    v_perm_b32 v145, v150, v146, s53
    v_perm_b32 v150, v150, v146, s54
    v_perm_b32 v146, v151, v147, s53
    v_perm_b32 v151, v151, v147, s54
    v_perm_b32 v147, v156, v152, s53
    v_perm_b32 v156, v156, v152, s54
    v_perm_b32 v152, v157, v153, s53
    v_perm_b32 v157, v157, v153, s54
    v_perm_b32 v153, v158, v154, s53
    v_perm_b32 v158, v158, v154, s54
    v_perm_b32 v154, v159, v155, s53
    v_perm_b32 v159, v159, v155, s54
L_poll1:
    s_mov_b32 s48, 4096
    buffer_load_dwordx4 v[84:87], v68, s[36:39], s48 offen sc1
    buffer_load_dwordx4 v[88:91], v68, s[36:39], s48 offen offset:16 sc1
    s_mov_b32 s48, 6144
    buffer_load_dwordx4 v[92:95], v68, s[36:39], s48 offen sc1
    buffer_load_dwordx4 v[96:99], v68, s[36:39], s48 offen offset:16 sc1
    s_waitcnt vmcnt(0)
    v_xor_b32 v100, s32, v85
    v_xor_b32 v87, s32, v87
    v_xor_b32 v89, s32, v89
    v_xor_b32 v91, s32, v91
    v_xor_b32 v93, s32, v93
    v_xor_b32 v95, s32, v95
    v_xor_b32 v97, s32, v97
    v_xor_b32 v99, s32, v99
    v_or3_b32 v100, v100, v87, v89
    v_or3_b32 v100, v100, v91, v93
    v_or3_b32 v100, v100, v95, v97
    v_or_b32 v100, v100, v99
    v_cmp_ne_u32 vcc, 0, v100
    s_cbranch_vccz L_pdone2
    s_mov_b64 exec, vcc
    s_sub_u32 s59, s59, 1
    s_cbranch_scc1 L_end
    s_sleep 1
    s_branch L_poll1
L_pdone2:
    s_mov_b64 exec, s[66:67]
    v_and_b32 v85, s52, v84
    v_lshlrev_b32 v84, 16, v84
    v_and_b32 v87, s52, v86
    v_lshlrev_b32 v86, 16, v86
    v_and_b32 v89, s52, v88
    v_lshlrev_b32 v88, 16, v88
    v_and_b32 v91, s52, v90
    v_lshlrev_b32 v90, 16, v90
    v_and_b32 v93, s52, v92
    v_lshlrev_b32 v92, 16, v92
    v_and_b32 v95, s52, v94
    v_lshlrev_b32 v94, 16, v94
    v_and_b32 v97, s52, v96
    v_lshlrev_b32 v96, 16, v96
    v_and_b32 v99, s52, v98
    v_lshlrev_b32 v98, 16, v98
    v_add_f32 v92, 1.0, v92
    v_add_f32 v93, 1.0, v93
    v_add_f32 v94, 1.0, v94
    v_add_f32 v95, 1.0, v95
    v_add_f32 v96, 1.0, v96
    v_add_f32 v97, 1.0, v97
    v_add_f32 v98, 1.0, v98
    v_add_f32 v99, 1.0, v99
    v_cvt_pk_bf16_f32 v93, v92, v93
    v_cvt_pk_bf16_f32 v95, v94, v95
    v_cvt_pk_bf16_f32 v97, v96, v97
    v_cvt_pk_bf16_f32 v99, v98, v99
    v_lshlrev_b32 v92, 16, v93
    v_and_b32 v93, s52, v93
    v_lshlrev_b32 v94, 16, v95
    v_and_b32 v95, s52, v95
    v_lshlrev_b32 v96, 16, v97
    v_and_b32 v97, s52, v97
    v_lshlrev_b32 v98, 16, v99
    v_and_b32 v99, s52, v99
    v_mul_f32 v76, v76, v92
    v_mul_f32 v77, v77, v93
    v_mul_f32 v78, v78, v94
    v_mul_f32 v79, v79, v95
    v_mul_f32 v80, v80, v96
    v_mul_f32 v81, v81, v97
    v_mul_f32 v82, v82, v98
    v_mul_f32 v83, v83, v99
    v_cvt_pk_bf16_f32 v77, v76, v77
    v_cvt_pk_bf16_f32 v79, v78, v79
    v_cvt_pk_bf16_f32 v81, v80, v81
    v_cvt_pk_bf16_f32 v83, v82, v83
    v_lshlrev_b32 v76, 16, v77
    v_and_b32 v77, s52, v77
    v_lshlrev_b32 v78, 16, v79
    v_and_b32 v79, s52, v79
    v_lshlrev_b32 v80, 16, v81
    v_and_b32 v81, s52, v81
    v_lshlrev_b32 v82, 16, v83
    v_and_b32 v83, s52, v83
    v_add_f32 v76, v76, v84
    v_add_f32 v77, v77, v85
    v_add_f32 v78, v78, v86
    v_add_f32 v79, v79, v87
    v_add_f32 v80, v80, v88
    v_add_f32 v81, v81, v89
    v_add_f32 v82, v82, v90
    v_add_f32 v83, v83, v91
    v_cvt_pk_bf16_f32 v72, v76, v77
    v_cvt_pk_bf16_f32 v73, v78, v79
    v_cvt_pk_bf16_f32 v74, v80, v81
    v_cvt_pk_bf16_f32 v75, v82, v83
L_pgemv:
    v_dot2_f32_bf16 v8, v127, v72, 0
    v_dot2_f32_bf16 v9, v132, v72, 0
    v_dot2_f32_bf16 v10, v128, v72, 0
    v_dot2_f32_bf16 v11, v133, v72, 0
    v_dot2_f32_bf16 v12, v129, v72, 0
    v_dot2_f32_bf16 v13, v134, v72, 0
    v_dot2_f32_bf16 v14, v130, v72, 0
    v_dot2_f32_bf16 v15, v135, v72, 0
    v_dot2_f32_bf16 v8, v131, v73, v8
    v_dot2_f32_bf16 v9, v140, v73, v9
    v_dot2_f32_bf16 v10, v136, v73, v10
    v_dot2_f32_bf16 v11, v141, v73, v11
    v_dot2_f32_bf16 v12, v137, v73, v12
    v_dot2_f32_bf16 v13, v142, v73, v13
    v_dot2_f32_bf16 v14, v138, v73, v14
    v_dot2_f32_bf16 v15, v143, v73, v15
    v_dot2_f32_bf16 v8, v139, v74, v8
    v_dot2_f32_bf16 v9, v148, v74, v9
    v_dot2_f32_bf16 v10, v144, v74, v10
    v_dot2_f32_bf16 v11, v149, v74, v11
    v_dot2_f32_bf16 v12, v145, v74, v12
    v_dot2_f32_bf16 v13, v150, v74, v13
    v_dot2_f32_bf16 v14, v146, v74, v14
    v_dot2_f32_bf16 v15, v151, v74, v15
    v_dot2_f32_bf16 v8, v147, v75, v8
    v_dot2_f32_bf16 v9, v156, v75, v9
    v_dot2_f32_bf16 v10, v152, v75, v10
    v_dot2_f32_bf16 v11, v157, v75, v11
    v_dot2_f32_bf16 v12, v153, v75, v12
    v_dot2_f32_bf16 v13, v158, v75, v13
    v_dot2_f32_bf16 v14, v154, v75, v14
    v_dot2_f32_bf16 v15, v159, v75, v15
    v_and_b32 v24, 15, v0
    v_lshlrev_b32 v24, 3, v24
    v_mov_b32 v23, 1
    v_permlane32_swap_b32 v8, v12
    v_permlane32_swap_b32 v9, v13
    v_permlane32_swap_b32 v10, v14
    v_permlane32_swap_b32 v11, v15
    v_add_f32 v8, v8, v12
    v_add_f32 v9, v9, v13
    v_add_f32 v10, v10, v14
    v_add_f32 v11, v11, v15
    s_nop 0
    v_permlane16_swap_b32 v8, v10
    v_permlane16_swap_b32 v9, v11
    v_add_f32 v8, v8, v10
    v_add_f32 v9, v9, v11
    s_nop 0
    v_add_f32_dpp v8, v8, v8 row_ror:8 row_mask:0xf bank_mask:0xf
    v_add_f32_dpp v9, v9, v9 row_ror:8 row_mask:0xf bank_mask:0xf
    s_nop 0
    v_add_f32_dpp v8, v8, v8 row_ror:4 row_mask:0xf bank_mask:0xf
    v_add_f32_dpp v9, v9, v9 row_ror:4 row_mask:0xf bank_mask:0xf
    ds_write_b64 v67, v[8:9] offset:512
    s_and_b64 exec, 1, s[66:67]
    ds_add_rtn_u32 v22, v3, v23 offset:0
    s_mov_b64 exec, s[66:67]
    ds_read_b64 v[26:27], v24 offset:512
    ds_read_b64 v[28:29], v24 offset:640
    ds_read_b64 v[30:31], v24 offset:768
    ds_read_b64 v[32:33], v24 offset:896
    s_waitcnt lgkmcnt(4)
    v_readfirstlane_b32 s35, v22
    s_xor_b32 s35, s35, 3
    s_and_b32 s35, s35, s66
    s_cbranch_scc1 L_getq
    s_waitcnt lgkmcnt(0)
    v_pk_add_f32 v[26:27], v[26:27], v[28:29]
    v_pk_add_f32 v[30:31], v[30:31], v[32:33]
    v_pk_add_f32 v[26:27], v[26:27], v[30:31]
    v_cvt_pk_bf16_f32 v26, v26, v27
    v_mov_b32 v27, s32
    s_lshl_b32 s35, s34, 7
    s_add_u32 s50, s50, s35
    s_mov_b64 exec, 0xffff
    buffer_store_dwordx2 v[26:27], v24, s[36:39], s50 offen sc1
    s_mov_b64 exec, -1
    s_branch L_getq
L_idle:
    s_barrier
    s_waitcnt vmcnt(0)
    v_readfirstlane_b32 s32, v64
    s_add_u32 s32, s32, 0x9e3779b9
L_getq:
    s_waitcnt lgkmcnt(0)
    s_mov_b32 s60, s26
    s_mov_b32 s61, s27
    s_mov_b32 s62, 1024
    s_mov_b32 s63, 0x20000
    s_mov_b32 s40, s12
    s_mov_b32 s41, s13
    s_mov_b32 s42, 0
    s_mov_b32 s43, 0x20000
    v_mov_b32 v116, 0
    v_mov_b32 v70, 0
    s_mov_b32 s90, 0
    v_mov_b32 v8, 0
    v_mov_b32 v9, 0
    v_mov_b32 v10, 0
    v_mov_b32 v11, 0
    v_mov_b32 v12, 0
    v_mov_b32 v13, 0
    v_mov_b32 v14, 0
    v_mov_b32 v15, 0
    v_mov_b32 v16, 0
    v_mov_b32 v17, 0xf149f2ca
    v_mul_f32 v18, s55, v17
    s_bfe_u32 s34, s91, 0x30001
    s_lshl_b32 s34, s34, 1
    s_lshr_b32 s35, s91, 4
    s_add_u32 s34, s34, s35
    s_lshl_b32 s34, s34, 2
    s_and_b32 s35, s69, 3
    s_add_u32 s34, s34, s35
    s_lshl_b32 s34, s34, 1
    s_and_b32 s35, s91, 1
    s_add_u32 s34, s34, s35
    s_lshl_b32 s49, s34, 6
    s_lshl_b32 s48, s91, 9
    s_add_u32 s48, s48, 16384
    v_and_b32 v24, 15, v0
    v_lshlrev_b32 v24, 5, v24
    s_mov_b32 s56, s33
    s_mul_i32 s57, s33, 1
    s_lshr_b32 s35, s91, 1
    s_mul_i32 s35, s35, 0
    s_add_u32 s57, s57, s35
    s_add_u32 s57, s57, 440
    s_lshl_b32 s50, s33, 13
    s_add_u32 s50, s50, 8192
    s_mov_b32 s92, 0
    s_lshl_b32 s35, s33, 2
    v_mov_b32 v19, s35
    v_and_b32 v118, 48, v0
    v_lshl_add_u32 v118, v19, 4, v118
    s_mov_b32 s64, 0x10001
    s_mov_b32 s65, 0x10001
    v_lshrrev_b32 v119, 2, v0
    v_lshlrev_b32 v119, 4, v119
    v_and_b32 v120, 1, v0
    v_lshl_add_u32 v119, v120, 3, v119
    v_and_b32 v120, 63, v119
    v_and_b32 v121, 2, v0
    v_lshl_add_u32 v119, v121, 7, v119
    v_lshl_add_u32 v120, v121, 9, v120
    v_lshlrev_b32 v119, 3, v0
    v_and_b32 v120, 15, v0
    v_lshlrev_b32 v120, 3, v120
    v_lshlrev_b32 v110, 3, v0
    v_lshl_add_u32 v110, v19, 7, v110
    v_lshrrev_b32 v111, 1, v110
    v_and_b32 v112, 31, v0
    v_lshlrev_b32 v113, 2, v112
    v_add_u32 v122, 0x80, v113
    v_lshlrev_b32 v114, 4, v19
    v_lshl_add_u32 v112, v112, 1, v114
    v_lshrrev_b32 v121, 4, v0
    v_lshl_add_u32 v114, v121, 4, v114
    v_and_b32 v115, 15, v0
    v_lshlrev_b32 v115, 5, v115
    v_lshl_add_u32 v115, v121, 3, v115
    v_add_u32 v2, s50, v1
    s_add_u32 s50, s50, 32768
    s_cmp_ge_u32 s50, 163840
    s_cselect_b32 s35, 139264, 0
    s_sub_u32 s50, s50, s35
L_pw32:
    ds_read_b32 v25, v3 offset:16
    s_sub_u32 s59, s59, 1
    s_cbranch_scc1 L_end
    s_waitcnt lgkmcnt(0)
    v_cmp_lt_i32 vcc, s56, v25
    s_cbranch_vccz L_pw32
    ds_read_b128 v[32:35], v2 offset:0
    ds_read_b128 v[36:39], v2 offset:1024
    ds_read_b128 v[40:43], v2 offset:2048
    ds_read_b128 v[44:47], v2 offset:3072
    ds_read_b128 v[48:51], v2 offset:4096
    ds_read_b128 v[52:55], v2 offset:5120
    ds_read_b128 v[56:59], v2 offset:6144
    ds_read_b128 v[60:63], v2 offset:7168
    s_add_u32 s56, s56, 4
    v_mov_b32 v26, s56
    s_waitcnt lgkmcnt(0)
    ds_write_b32 v19, v26 offset:32
    v_add_u32 v2, s50, v1
    s_add_u32 s50, s50, 32768
    s_cmp_ge_u32 s50, 163840
    s_cselect_b32 s35, 139264, 0
    s_sub_u32 s50, s50, s35
L_pw224:
    ds_read_b32 v25, v3 offset:16
    s_sub_u32 s59, s59, 1
    s_cbranch_scc1 L_end
    s_waitcnt lgkmcnt(0)
    v_cmp_lt_i32 vcc, s56, v25
    s_cbranch_vccz L_pw224
    ds_read_b128 v[224:227], v2 offset:0
    ds_read_b128 v[228:231], v2 offset:1024
    ds_read_b128 v[232:235], v2 offset:2048
    ds_read_b128 v[236:239], v2 offset:3072
    ds_read_b128 v[240:243], v2 offset:4096
    ds_read_b128 v[244:247], v2 offset:5120
    ds_read_b128 v[248:251], v2 offset:6144
    ds_read_b128 v[252:255], v2 offset:7168
    s_add_u32 s56, s56, 4
    v_mov_b32 v26, s56
    s_waitcnt lgkmcnt(0)
    ds_write_b32 v19, v26 offset:32
    v_add_u32 v2, s50, v1
    s_add_u32 s50, s50, 32768
    s_cmp_ge_u32 s50, 163840
    s_cselect_b32 s35, 139264, 0
    s_sub_u32 s50, s50, s35
L_pw128:
    ds_read_b32 v25, v3 offset:16
    s_sub_u32 s59, s59, 1
    s_cbranch_scc1 L_end
    s_waitcnt lgkmcnt(0)
    v_cmp_lt_i32 vcc, s56, v25
    s_cbranch_vccz L_pw128
    ds_read_b128 v[128:131], v2 offset:0
    ds_read_b128 v[132:135], v2 offset:1024
    ds_read_b128 v[136:139], v2 offset:2048
    ds_read_b128 v[140:143], v2 offset:3072
    ds_read_b128 v[144:147], v2 offset:4096
    ds_read_b128 v[148:151], v2 offset:5120
    ds_read_b128 v[152:155], v2 offset:6144
    ds_read_b128 v[156:159], v2 offset:7168
    s_add_u32 s56, s56, 4
    v_mov_b32 v26, s56
    s_waitcnt lgkmcnt(0)
    ds_write_b32 v19, v26 offset:32
    v_add_u32 v2, s50, v1
    s_add_u32 s50, s50, 32768
    s_cmp_ge_u32 s50, 163840
    s_cselect_b32 s35, 139264, 0
    s_sub_u32 s50, s50, s35
L_pw160:
    ds_read_b32 v25, v3 offset:16
    s_sub_u32 s59, s59, 1
    s_cbranch_scc1 L_end
    s_waitcnt lgkmcnt(0)
    v_cmp_lt_i32 vcc, s56, v25
    s_cbranch_vccz L_pw160
    ds_read_b128 v[160:163], v2 offset:0
    ds_read_b128 v[164:167], v2 offset:1024
    ds_read_b128 v[168:171], v2 offset:2048
    ds_read_b128 v[172:175], v2 offset:3072
    ds_read_b128 v[176:179], v2 offset:4096
    ds_read_b128 v[180:183], v2 offset:5120
    ds_read_b128 v[184:187], v2 offset:6144
    ds_read_b128 v[188:191], v2 offset:7168
    s_add_u32 s56, s56, 4
    v_mov_b32 v26, s56
    s_waitcnt lgkmcnt(0)
    ds_write_b32 v19, v26 offset:32
    v_add_u32 v2, s50, v1
    s_add_u32 s50, s50, 32768
    s_cmp_ge_u32 s50, 163840
    s_cselect_b32 s35, 139264, 0
    s_sub_u32 s50, s50, s35
L_pw192:
    ds_read_b32 v25, v3 offset:16
    s_sub_u32 s59, s59, 1
    s_cbranch_scc1 L_end
    s_waitcnt lgkmcnt(0)
    v_cmp_lt_i32 vcc, s56, v25
    s_cbranch_vccz L_pw192
    ds_read_b128 v[192:195], v2 offset:0
    ds_read_b128 v[196:199], v2 offset:1024
    ds_read_b128 v[200:203], v2 offset:2048
    ds_read_b128 v[204:207], v2 offset:3072
    ds_read_b128 v[208:211], v2 offset:4096
    ds_read_b128 v[212:215], v2 offset:5120
    ds_read_b128 v[216:219], v2 offset:6144
    ds_read_b128 v[220:223], v2 offset:7168
    s_add_u32 s56, s56, 4
    v_mov_b32 v26, s56
    s_waitcnt lgkmcnt(0)
    ds_write_b32 v19, v26 offset:32
L_poll3:
    buffer_load_dwordx4 v[72:75], v24, s[36:39], s48 offen sc1
    buffer_load_dwordx4 v[76:79], v24, s[36:39], s48 offen offset:16 sc1
    s_waitcnt vmcnt(0)
    v_xor_b32 v25, s32, v73
    v_xor_b32 v75, s32, v75
    v_xor_b32 v77, s32, v77
    v_xor_b32 v79, s32, v79
    v_or3_b32 v25, v25, v75, v77
    v_or_b32 v25, v25, v79
    v_cmp_ne_u32 vcc, 0, v25
    s_cbranch_vccz L_pdone4
    s_mov_b64 exec, vcc
    s_sub_u32 s59, s59, 1
    s_cbranch_scc1 L_end
    s_sleep 4
    s_branch L_poll3
L_pdone4:
    s_mov_b64 exec, s[66:67]
    v_mov_b32 v4, v72
    v_mov_b32 v5, v74
    v_mov_b32 v6, v76
    v_mov_b32 v7, v78
    v_dot2_f32_bf16 v8, v32, v4, 0
    v_dot2_f32_bf16 v9, v36, v4, 0
    v_dot2_f32_bf16 v10, v40, v4, 0
    v_dot2_f32_bf16 v11, v44, v4, 0
    v_dot2_f32_bf16 v12, v48, v4, 0
    v_dot2_f32_bf16 v13, v52, v4, 0
    v_dot2_f32_bf16 v14, v56, v4, 0
    v_dot2_f32_bf16 v15, v60, v4, 0
    v_dot2_f32_bf16 v8, v33, v5, v8
    v_dot2_f32_bf16 v9, v37, v5, v9
    v_dot2_f32_bf16 v10, v41, v5, v10
    v_dot2_f32_bf16 v11, v45, v5, v11
    v_dot2_f32_bf16 v12, v49, v5, v12
    v_dot2_f32_bf16 v13, v53, v5, v13
    v_dot2_f32_bf16 v14, v57, v5, v14
    v_dot2_f32_bf16 v15, v61, v5, v15
    v_dot2_f32_bf16 v8, v34, v6, v8
    v_dot2_f32_bf16 v9, v38, v6, v9
    v_dot2_f32_bf16 v10, v42, v6, v10
    v_dot2_f32_bf16 v11, v46, v6, v11
    v_dot2_f32_bf16 v12, v50, v6, v12
    v_dot2_f32_bf16 v13, v54, v6, v13
    v_dot2_f32_bf16 v14, v58, v6, v14
    v_dot2_f32_bf16 v15, v62, v6, v15
    v_dot2_f32_bf16 v8, v35, v7, v8
    v_dot2_f32_bf16 v9, v39, v7, v9
    v_dot2_f32_bf16 v10, v43, v7, v10
    v_dot2_f32_bf16 v11, v47, v7, v11
    v_dot2_f32_bf16 v12, v51, v7, v12
    v_dot2_f32_bf16 v13, v55, v7, v13
    v_dot2_f32_bf16 v14, v59, v7, v14
    v_dot2_f32_bf16 v15, v63, v7, v15
    v_add_f32_dpp v8, v8, v8 row_ror:8 row_mask:0xf bank_mask:0xf
    v_add_f32_dpp v9, v9, v9 row_ror:8 row_mask:0xf bank_mask:0xf
    v_add_f32_dpp v10, v10, v10 row_ror:8 row_mask:0xf bank_mask:0xf
    v_add_f32_dpp v11, v11, v11 row_ror:8 row_mask:0xf bank_mask:0xf
    v_add_f32_dpp v12, v12, v12 row_ror:8 row_mask:0xf bank_mask:0xf
    v_add_f32_dpp v13, v13, v13 row_ror:8 row_mask:0xf bank_mask:0xf
    v_add_f32_dpp v14, v14, v14 row_ror:8 row_mask:0xf bank_mask:0xf
    v_add_f32_dpp v15, v15, v15 row_ror:8 row_mask:0xf bank_mask:0xf
    v_add_f32_dpp v8, v8, v8 row_ror:4 row_mask:0xf bank_mask:0xf
    v_add_f32_dpp v9, v9, v9 row_ror:4 row_mask:0xf bank_mask:0xf
    v_add_f32_dpp v10, v10, v10 row_ror:4 row_mask:0xf bank_mask:0xf
    v_add_f32_dpp v11, v11, v11 row_ror:4 row_mask:0xf bank_mask:0xf
    v_add_f32_dpp v12, v12, v12 row_ror:4 row_mask:0xf bank_mask:0xf
    v_add_f32_dpp v13, v13, v13 row_ror:4 row_mask:0xf bank_mask:0xf
    v_add_f32_dpp v14, v14, v14 row_ror:4 row_mask:0xf bank_mask:0xf
    v_add_f32_dpp v15, v15, v15 row_ror:4 row_mask:0xf bank_mask:0xf
    v_add_f32_dpp v8, v8, v8 row_ror:2 row_mask:0xf bank_mask:0xf
    v_add_f32_dpp v9, v9, v9 row_ror:2 row_mask:0xf bank_mask:0xf
    v_add_f32_dpp v10, v10, v10 row_ror:2 row_mask:0xf bank_mask:0xf
    v_add_f32_dpp v11, v11, v11 row_ror:2 row_mask:0xf bank_mask:0xf
    v_add_f32_dpp v12, v12, v12 row_ror:2 row_mask:0xf bank_mask:0xf
    v_add_f32_dpp v13, v13, v13 row_ror:2 row_mask:0xf bank_mask:0xf
    v_add_f32_dpp v14, v14, v14 row_ror:2 row_mask:0xf bank_mask:0xf
    v_add_f32_dpp v15, v15, v15 row_ror:2 row_mask:0xf bank_mask:0xf
    v_add_f32_dpp v8, v8, v8 row_ror:1 row_mask:0xf bank_mask:0xf
    v_add_f32_dpp v9, v9, v9 row_ror:1 row_mask:0xf bank_mask:0xf
    v_add_f32_dpp v10, v10, v10 row_ror:1 row_mask:0xf bank_mask:0xf
    v_add_f32_dpp v11, v11, v11 row_ror:1 row_mask:0xf bank_mask:0xf
    v_add_f32_dpp v12, v12, v12 row_ror:1 row_mask:0xf bank_mask:0xf
    v_add_f32_dpp v13, v13, v13 row_ror:1 row_mask:0xf bank_mask:0xf
    v_add_f32_dpp v14, v14, v14 row_ror:1 row_mask:0xf bank_mask:0xf
    v_add_f32_dpp v15, v15, v15 row_ror:1 row_mask:0xf bank_mask:0xf
    v_cvt_pk_bf16_f32 v9, v8, v9
    v_cvt_pk_bf16_f32 v11, v10, v11
    v_cvt_pk_bf16_f32 v13, v12, v13
    v_cvt_pk_bf16_f32 v15, v14, v15
    v_lshlrev_b32 v8, 16, v9
    v_and_b32 v9, s52, v9
    v_lshlrev_b32 v10, 16, v11
    v_and_b32 v11, s52, v11
    v_lshlrev_b32 v12, 16, v13
    v_and_b32 v13, s52, v13
    v_lshlrev_b32 v14, 16, v15
    v_and_b32 v15, s52, v15
    v_mul_f32 v8, s58, v8
    v_mul_f32 v9, s58, v9
    v_mul_f32 v10, s58, v10
    v_mul_f32 v11, s58, v11
    v_mul_f32 v12, s58, v12
    v_mul_f32 v13, s58, v13
    v_mul_f32 v14, s58, v14
    v_mul_f32 v15, s58, v15
    v_cvt_pk_bf16_f32 v20, v8, v9
    v_cvt_pk_bf16_f32 v21, v10, v11
    v_cvt_pk_bf16_f32 v22, v12, v13
    v_cvt_pk_bf16_f32 v23, v14, v15
    v_max3_f32 v17, v8, v9, v17
    v_max3_f32 v17, v10, v11, v17
    v_max3_f32 v17, v12, v13, v17
    v_max3_f32 v17, v14, v15, v17
    s_mov_b64 exec, s[64:65]
    ds_write_b128 v118, v[20:23] offset:4096
    s_mov_b64 exec, -1
    v_add_u32 v118, 0x100, v118
    v_dot2_f32_bf16 v8, v224, v4, 0
    v_dot2_f32_bf16 v9, v228, v4, 0
    v_dot2_f32_bf16 v10, v232, v4, 0
    v_dot2_f32_bf16 v11, v236, v4, 0
    v_dot2_f32_bf16 v12, v240, v4, 0
    v_dot2_f32_bf16 v13, v244, v4, 0
    v_dot2_f32_bf16 v14, v248, v4, 0
    v_dot2_f32_bf16 v15, v252, v4, 0
    v_dot2_f32_bf16 v8, v225, v5, v8
    v_dot2_f32_bf16 v9, v229, v5, v9
    v_dot2_f32_bf16 v10, v233, v5, v10
    v_dot2_f32_bf16 v11, v237, v5, v11
    v_dot2_f32_bf16 v12, v241, v5, v12
    v_dot2_f32_bf16 v13, v245, v5, v13
    v_dot2_f32_bf16 v14, v249, v5, v14
    v_dot2_f32_bf16 v15, v253, v5, v15
    v_dot2_f32_bf16 v8, v226, v6, v8
    v_dot2_f32_bf16 v9, v230, v6, v9
    v_dot2_f32_bf16 v10, v234, v6, v10
    v_dot2_f32_bf16 v11, v238, v6, v11
    v_dot2_f32_bf16 v12, v242, v6, v12
    v_dot2_f32_bf16 v13, v246, v6, v13
    v_dot2_f32_bf16 v14, v250, v6, v14
    v_dot2_f32_bf16 v15, v254, v6, v15
    v_dot2_f32_bf16 v8, v227, v7, v8
    v_dot2_f32_bf16 v9, v231, v7, v9
    v_dot2_f32_bf16 v10, v235, v7, v10
    v_dot2_f32_bf16 v11, v239, v7, v11
    v_dot2_f32_bf16 v12, v243, v7, v12
    v_dot2_f32_bf16 v13, v247, v7, v13
    v_dot2_f32_bf16 v14, v251, v7, v14
    v_dot2_f32_bf16 v15, v255, v7, v15
    v_add_f32_dpp v8, v8, v8 row_ror:8 row_mask:0xf bank_mask:0xf
    v_add_f32_dpp v9, v9, v9 row_ror:8 row_mask:0xf bank_mask:0xf
    v_add_f32_dpp v10, v10, v10 row_ror:8 row_mask:0xf bank_mask:0xf
    v_add_f32_dpp v11, v11, v11 row_ror:8 row_mask:0xf bank_mask:0xf
    v_add_f32_dpp v12, v12, v12 row_ror:8 row_mask:0xf bank_mask:0xf
    v_add_f32_dpp v13, v13, v13 row_ror:8 row_mask:0xf bank_mask:0xf
    v_add_f32_dpp v14, v14, v14 row_ror:8 row_mask:0xf bank_mask:0xf
    v_add_f32_dpp v15, v15, v15 row_ror:8 row_mask:0xf bank_mask:0xf
    v_add_f32_dpp v8, v8, v8 row_ror:4 row_mask:0xf bank_mask:0xf
    v_add_f32_dpp v9, v9, v9 row_ror:4 row_mask:0xf bank_mask:0xf
    v_add_f32_dpp v10, v10, v10 row_ror:4 row_mask:0xf bank_mask:0xf
    v_add_f32_dpp v11, v11, v11 row_ror:4 row_mask:0xf bank_mask:0xf
    v_add_f32_dpp v12, v12, v12 row_ror:4 row_mask:0xf bank_mask:0xf
    v_add_f32_dpp v13, v13, v13 row_ror:4 row_mask:0xf bank_mask:0xf
    v_add_f32_dpp v14, v14, v14 row_ror:4 row_mask:0xf bank_mask:0xf
    v_add_f32_dpp v15, v15, v15 row_ror:4 row_mask:0xf bank_mask:0xf
    v_add_f32_dpp v8, v8, v8 row_ror:2 row_mask:0xf bank_mask:0xf
    v_add_f32_dpp v9, v9, v9 row_ror:2 row_mask:0xf bank_mask:0xf
    v_add_f32_dpp v10, v10, v10 row_ror:2 row_mask:0xf bank_mask:0xf
    v_add_f32_dpp v11, v11, v11 row_ror:2 row_mask:0xf bank_mask:0xf
    v_add_f32_dpp v12, v12, v12 row_ror:2 row_mask:0xf bank_mask:0xf
    v_add_f32_dpp v13, v13, v13 row_ror:2 row_mask:0xf bank_mask:0xf
    v_add_f32_dpp v14, v14, v14 row_ror:2 row_mask:0xf bank_mask:0xf
    v_add_f32_dpp v15, v15, v15 row_ror:2 row_mask:0xf bank_mask:0xf
    v_add_f32_dpp v8, v8, v8 row_ror:1 row_mask:0xf bank_mask:0xf
    v_add_f32_dpp v9, v9, v9 row_ror:1 row_mask:0xf bank_mask:0xf
    v_add_f32_dpp v10, v10, v10 row_ror:1 row_mask:0xf bank_mask:0xf
    v_add_f32_dpp v11, v11, v11 row_ror:1 row_mask:0xf bank_mask:0xf
    v_add_f32_dpp v12, v12, v12 row_ror:1 row_mask:0xf bank_mask:0xf
    v_add_f32_dpp v13, v13, v13 row_ror:1 row_mask:0xf bank_mask:0xf
    v_add_f32_dpp v14, v14, v14 row_ror:1 row_mask:0xf bank_mask:0xf
    v_add_f32_dpp v15, v15, v15 row_ror:1 row_mask:0xf bank_mask:0xf
    v_cvt_pk_bf16_f32 v9, v8, v9
    v_cvt_pk_bf16_f32 v11, v10, v11
    v_cvt_pk_bf16_f32 v13, v12, v13
    v_cvt_pk_bf16_f32 v15, v14, v15
    v_lshlrev_b32 v8, 16, v9
    v_and_b32 v9, s52, v9
    v_lshlrev_b32 v10, 16, v11
    v_and_b32 v11, s52, v11
    v_lshlrev_b32 v12, 16, v13
    v_and_b32 v13, s52, v13
    v_lshlrev_b32 v14, 16, v15
    v_and_b32 v15, s52, v15
    v_mul_f32 v8, s58, v8
    v_mul_f32 v9, s58, v9
    v_mul_f32 v10, s58, v10
    v_mul_f32 v11, s58, v11
    v_mul_f32 v12, s58, v12
    v_mul_f32 v13, s58, v13
    v_mul_f32 v14, s58, v14
    v_mul_f32 v15, s58, v15
    v_cvt_pk_bf16_f32 v20, v8, v9
    v_cvt_pk_bf16_f32 v21, v10, v11
    v_cvt_pk_bf16_f32 v22, v12, v13
    v_cvt_pk_bf16_f32 v23, v14, v15
    v_max3_f32 v17, v8, v9, v17
    v_max3_f32 v17, v10, v11, v17
    v_max3_f32 v17, v12, v13, v17
    v_max3_f32 v17, v14, v15, v17
    s_mov_b64 exec, s[64:65]
    ds_write_b128 v118, v[20:23] offset:4096
    s_mov_b64 exec, -1
    v_add_u32 v118, 0x100, v118
    v_dot2_f32_bf16 v8, v128, v4, 0
    v_dot2_f32_bf16 v9, v132, v4, 0
    v_dot2_f32_bf16 v10, v136, v4, 0
    v_dot2_f32_bf16 v11, v140, v4, 0
    v_dot2_f32_bf16 v12, v144, v4, 0
    v_dot2_f32_bf16 v13, v148, v4, 0
    v_dot2_f32_bf16 v14, v152, v4, 0
    v_dot2_f32_bf16 v15, v156, v4, 0
    v_dot2_f32_bf16 v8, v129, v5, v8
    v_dot2_f32_bf16 v9, v133, v5, v9
    v_dot2_f32_bf16 v10, v137, v5, v10
    v_dot2_f32_bf16 v11, v141, v5, v11
    v_dot2_f32_bf16 v12, v145, v5, v12
    v_dot2_f32_bf16 v13, v149, v5, v13
    v_dot2_f32_bf16 v14, v153, v5, v14
    v_dot2_f32_bf16 v15, v157, v5, v15
    v_dot2_f32_bf16 v8, v130, v6, v8
    v_dot2_f32_bf16 v9, v134, v6, v9
    v_dot2_f32_bf16 v10, v138, v6, v10
    v_dot2_f32_bf16 v11, v142, v6, v11
    v_dot2_f32_bf16 v12, v146, v6, v12
    v_dot2_f32_bf16 v13, v150, v6, v13
    v_dot2_f32_bf16 v14, v154, v6, v14
    v_dot2_f32_bf16 v15, v158, v6, v15
    v_dot2_f32_bf16 v8, v131, v7, v8
    v_dot2_f32_bf16 v9, v135, v7, v9
    v_dot2_f32_bf16 v10, v139, v7, v10
    v_dot2_f32_bf16 v11, v143, v7, v11
    v_dot2_f32_bf16 v12, v147, v7, v12
    v_dot2_f32_bf16 v13, v151, v7, v13
    v_dot2_f32_bf16 v14, v155, v7, v14
    v_dot2_f32_bf16 v15, v159, v7, v15
    v_add_f32_dpp v8, v8, v8 row_ror:8 row_mask:0xf bank_mask:0xf
    v_add_f32_dpp v9, v9, v9 row_ror:8 row_mask:0xf bank_mask:0xf
    v_add_f32_dpp v10, v10, v10 row_ror:8 row_mask:0xf bank_mask:0xf
    v_add_f32_dpp v11, v11, v11 row_ror:8 row_mask:0xf bank_mask:0xf
    v_add_f32_dpp v12, v12, v12 row_ror:8 row_mask:0xf bank_mask:0xf
    v_add_f32_dpp v13, v13, v13 row_ror:8 row_mask:0xf bank_mask:0xf
    v_add_f32_dpp v14, v14, v14 row_ror:8 row_mask:0xf bank_mask:0xf
    v_add_f32_dpp v15, v15, v15 row_ror:8 row_mask:0xf bank_mask:0xf
    v_add_f32_dpp v8, v8, v8 row_ror:4 row_mask:0xf bank_mask:0xf
    v_add_f32_dpp v9, v9, v9 row_ror:4 row_mask:0xf bank_mask:0xf
    v_add_f32_dpp v10, v10, v10 row_ror:4 row_mask:0xf bank_mask:0xf
    v_add_f32_dpp v11, v11, v11 row_ror:4 row_mask:0xf bank_mask:0xf
    v_add_f32_dpp v12, v12, v12 row_ror:4 row_mask:0xf bank_mask:0xf
    v_add_f32_dpp v13, v13, v13 row_ror:4 row_mask:0xf bank_mask:0xf
    v_add_f32_dpp v14, v14, v14 row_ror:4 row_mask:0xf bank_mask:0xf
    v_add_f32_dpp v15, v15, v15 row_ror:4 row_mask:0xf bank_mask:0xf
    v_add_f32_dpp v8, v8, v8 row_ror:2 row_mask:0xf bank_mask:0xf
    v_add_f32_dpp v9, v9, v9 row_ror:2 row_mask:0xf bank_mask:0xf
    v_add_f32_dpp v10, v10, v10 row_ror:2 row_mask:0xf bank_mask:0xf
    v_add_f32_dpp v11, v11, v11 row_ror:2 row_mask:0xf bank_mask:0xf
    v_add_f32_dpp v12, v12, v12 row_ror:2 row_mask:0xf bank_mask:0xf
    v_add_f32_dpp v13, v13, v13 row_ror:2 row_mask:0xf bank_mask:0xf
    v_add_f32_dpp v14, v14, v14 row_ror:2 row_mask:0xf bank_mask:0xf
    v_add_f32_dpp v15, v15, v15 row_ror:2 row_mask:0xf bank_mask:0xf
    v_add_f32_dpp v8, v8, v8 row_ror:1 row_mask:0xf bank_mask:0xf
    v_add_f32_dpp v9, v9, v9 row_ror:1 row_mask:0xf bank_mask:0xf
    v_add_f32_dpp v10, v10, v10 row_ror:1 row_mask:0xf bank_mask:0xf
    v_add_f32_dpp v11, v11, v11 row_ror:1 row_mask:0xf bank_mask:0xf
    v_add_f32_dpp v12, v12, v12 row_ror:1 row_mask:0xf bank_mask:0xf
    v_add_f32_dpp v13, v13, v13 row_ror:1 row_mask:0xf bank_mask:0xf
    v_add_f32_dpp v14, v14, v14 row_ror:1 row_mask:0xf bank_mask:0xf
    v_add_f32_dpp v15, v15, v15 row_ror:1 row_mask:0xf bank_mask:0xf
    v_cvt_pk_bf16_f32 v9, v8, v9
    v_cvt_pk_bf16_f32 v11, v10, v11
    v_cvt_pk_bf16_f32 v13, v12, v13
    v_cvt_pk_bf16_f32 v15, v14, v15
    v_lshlrev_b32 v8, 16, v9
    v_and_b32 v9, s52, v9
    v_lshlrev_b32 v10, 16, v11
    v_and_b32 v11, s52, v11
    v_lshlrev_b32 v12, 16, v13
    v_and_b32 v13, s52, v13
    v_lshlrev_b32 v14, 16, v15
    v_and_b32 v15, s52, v15
    v_mul_f32 v8, s58, v8
    v_mul_f32 v9, s58, v9
    v_mul_f32 v10, s58, v10
    v_mul_f32 v11, s58, v11
    v_mul_f32 v12, s58, v12
    v_mul_f32 v13, s58, v13
    v_mul_f32 v14, s58, v14
    v_mul_f32 v15, s58, v15
    v_cvt_pk_bf16_f32 v20, v8, v9
    v_cvt_pk_bf16_f32 v21, v10, v11
    v_cvt_pk_bf16_f32 v22, v12, v13
    v_cvt_pk_bf16_f32 v23, v14, v15
    v_max3_f32 v17, v8, v9, v17
    v_max3_f32 v17, v10, v11, v17
    v_max3_f32 v17, v12, v13, v17
    v_max3_f32 v17, v14, v15, v17
    s_mov_b64 exec, s[64:65]
    ds_write_b128 v118, v[20:23] offset:4096
    s_mov_b64 exec, -1
    v_add_u32 v118, 0x100, v118
    v_dot2_f32_bf16 v8, v160, v4, 0
    v_dot2_f32_bf16 v9, v164, v4, 0
    v_dot2_f32_bf16 v10, v168, v4, 0
    v_dot2_f32_bf16 v11, v172, v4, 0
    v_dot2_f32_bf16 v12, v176, v4, 0
    v_dot2_f32_bf16 v13, v180, v4, 0
    v_dot2_f32_bf16 v14, v184, v4, 0
    v_dot2_f32_bf16 v15, v188, v4, 0
    v_dot2_f32_bf16 v8, v161, v5, v8
    v_dot2_f32_bf16 v9, v165, v5, v9
    v_dot2_f32_bf16 v10, v169, v5, v10
    v_dot2_f32_bf16 v11, v173, v5, v11
    v_dot2_f32_bf16 v12, v177, v5, v12
    v_dot2_f32_bf16 v13, v181, v5, v13
    v_dot2_f32_bf16 v14, v185, v5, v14
    v_dot2_f32_bf16 v15, v189, v5, v15
    v_dot2_f32_bf16 v8, v162, v6, v8
    v_dot2_f32_bf16 v9, v166, v6, v9
    v_dot2_f32_bf16 v10, v170, v6, v10
    v_dot2_f32_bf16 v11, v174, v6, v11
    v_dot2_f32_bf16 v12, v178, v6, v12
    v_dot2_f32_bf16 v13, v182, v6, v13
    v_dot2_f32_bf16 v14, v186, v6, v14
    v_dot2_f32_bf16 v15, v190, v6, v15
    v_dot2_f32_bf16 v8, v163, v7, v8
    v_dot2_f32_bf16 v9, v167, v7, v9
    v_dot2_f32_bf16 v10, v171, v7, v10
    v_dot2_f32_bf16 v11, v175, v7, v11
    v_dot2_f32_bf16 v12, v179, v7, v12
    v_dot2_f32_bf16 v13, v183, v7, v13
    v_dot2_f32_bf16 v14, v187, v7, v14
    v_dot2_f32_bf16 v15, v191, v7, v15
    v_add_f32_dpp v8, v8, v8 row_ror:8 row_mask:0xf bank_mask:0xf
    v_add_f32_dpp v9, v9, v9 row_ror:8 row_mask:0xf bank_mask:0xf
    v_add_f32_dpp v10, v10, v10 row_ror:8 row_mask:0xf bank_mask:0xf
    v_add_f32_dpp v11, v11, v11 row_ror:8 row_mask:0xf bank_mask:0xf
    v_add_f32_dpp v12, v12, v12 row_ror:8 row_mask:0xf bank_mask:0xf
    v_add_f32_dpp v13, v13, v13 row_ror:8 row_mask:0xf bank_mask:0xf
    v_add_f32_dpp v14, v14, v14 row_ror:8 row_mask:0xf bank_mask:0xf
    v_add_f32_dpp v15, v15, v15 row_ror:8 row_mask:0xf bank_mask:0xf
    v_add_f32_dpp v8, v8, v8 row_ror:4 row_mask:0xf bank_mask:0xf
    v_add_f32_dpp v9, v9, v9 row_ror:4 row_mask:0xf bank_mask:0xf
    v_add_f32_dpp v10, v10, v10 row_ror:4 row_mask:0xf bank_mask:0xf
    v_add_f32_dpp v11, v11, v11 row_ror:4 row_mask:0xf bank_mask:0xf
    v_add_f32_dpp v12, v12, v12 row_ror:4 row_mask:0xf bank_mask:0xf
    v_add_f32_dpp v13, v13, v13 row_ror:4 row_mask:0xf bank_mask:0xf
    v_add_f32_dpp v14, v14, v14 row_ror:4 row_mask:0xf bank_mask:0xf
    v_add_f32_dpp v15, v15, v15 row_ror:4 row_mask:0xf bank_mask:0xf
    v_add_f32_dpp v8, v8, v8 row_ror:2 row_mask:0xf bank_mask:0xf
    v_add_f32_dpp v9, v9, v9 row_ror:2 row_mask:0xf bank_mask:0xf
    v_add_f32_dpp v10, v10, v10 row_ror:2 row_mask:0xf bank_mask:0xf
    v_add_f32_dpp v11, v11, v11 row_ror:2 row_mask:0xf bank_mask:0xf
    v_add_f32_dpp v12, v12, v12 row_ror:2 row_mask:0xf bank_mask:0xf
    v_add_f32_dpp v13, v13, v13 row_ror:2 row_mask:0xf bank_mask:0xf
    v_add_f32_dpp v14, v14, v14 row_ror:2 row_mask:0xf bank_mask:0xf
    v_add_f32_dpp v15, v15, v15 row_ror:2 row_mask:0xf bank_mask:0xf
    v_add_f32_dpp v8, v8, v8 row_ror:1 row_mask:0xf bank_mask:0xf
    v_add_f32_dpp v9, v9, v9 row_ror:1 row_mask:0xf bank_mask:0xf
    v_add_f32_dpp v10, v10, v10 row_ror:1 row_mask:0xf bank_mask:0xf
    v_add_f32_dpp v11, v11, v11 row_ror:1 row_mask:0xf bank_mask:0xf
    v_add_f32_dpp v12, v12, v12 row_ror:1 row_mask:0xf bank_mask:0xf
    v_add_f32_dpp v13, v13, v13 row_ror:1 row_mask:0xf bank_mask:0xf
    v_add_f32_dpp v14, v14, v14 row_ror:1 row_mask:0xf bank_mask:0xf
    v_add_f32_dpp v15, v15, v15 row_ror:1 row_mask:0xf bank_mask:0xf
    v_cvt_pk_bf16_f32 v9, v8, v9
    v_cvt_pk_bf16_f32 v11, v10, v11
    v_cvt_pk_bf16_f32 v13, v12, v13
    v_cvt_pk_bf16_f32 v15, v14, v15
    v_lshlrev_b32 v8, 16, v9
    v_and_b32 v9, s52, v9
    v_lshlrev_b32 v10, 16, v11
    v_and_b32 v11, s52, v11
    v_lshlrev_b32 v12, 16, v13
    v_and_b32 v13, s52, v13
    v_lshlrev_b32 v14, 16, v15
    v_and_b32 v15, s52, v15
    v_mul_f32 v8, s58, v8
    v_mul_f32 v9, s58, v9
    v_mul_f32 v10, s58, v10
    v_mul_f32 v11, s58, v11
    v_mul_f32 v12, s58, v12
    v_mul_f32 v13, s58, v13
    v_mul_f32 v14, s58, v14
    v_mul_f32 v15, s58, v15
    v_cvt_pk_bf16_f32 v20, v8, v9
    v_cvt_pk_bf16_f32 v21, v10, v11
    v_cvt_pk_bf16_f32 v22, v12, v13
    v_cvt_pk_bf16_f32 v23, v14, v15
    v_max3_f32 v17, v8, v9, v17
    v_max3_f32 v17, v10, v11, v17
    v_max3_f32 v17, v12, v13, v17
    v_max3_f32 v17, v14, v15, v17
    s_mov_b64 exec, s[64:65]
    ds_write_b128 v118, v[20:23] offset:4096
    s_mov_b64 exec, -1
    v_add_u32 v118, 0x100, v118
    v_dot2_f32_bf16 v8, v192, v4, 0
    v_dot2_f32_bf16 v9, v196, v4, 0
    v_dot2_f32_bf16 v10, v200, v4, 0
    v_dot2_f32_bf16 v11, v204, v4, 0
    v_dot2_f32_bf16 v12, v208, v4, 0
    v_dot2_f32_bf16 v13, v212, v4, 0
    v_dot2_f32_bf16 v14, v216, v4, 0
    v_dot2_f32_bf16 v15, v220, v4, 0
    v_dot2_f32_bf16 v8, v193, v5, v8
    v_dot2_f32_bf16 v9, v197, v5, v9
    v_dot2_f32_bf16 v10, v201, v5, v10
    v_dot2_f32_bf16 v11, v205, v5, v11
    v_dot2_f32_bf16 v12, v209, v5, v12
    v_dot2_f32_bf16 v13, v213, v5, v13
    v_dot2_f32_bf16 v14, v217, v5, v14
    v_dot2_f32_bf16 v15, v221, v5, v15
    v_dot2_f32_bf16 v8, v194, v6, v8
    v_dot2_f32_bf16 v9, v198, v6, v9
    v_dot2_f32_bf16 v10, v202, v6, v10
    v_dot2_f32_bf16 v11, v206, v6, v11
    v_dot2_f32_bf16 v12, v210, v6, v12
    v_dot2_f32_bf16 v13, v214, v6, v13
    v_dot2_f32_bf16 v14, v218, v6, v14
    v_dot2_f32_bf16 v15, v222, v6, v15
    v_dot2_f32_bf16 v8, v195, v7, v8
    v_dot2_f32_bf16 v9, v199, v7, v9
    v_dot2_f32_bf16 v10, v203, v7, v10
    v_dot2_f32_bf16 v11, v207, v7, v11
    v_dot2_f32_bf16 v12, v211, v7, v12
    v_dot2_f32_bf16 v13, v215, v7, v13
    v_dot2_f32_bf16 v14, v219, v7, v14
    v_dot2_f32_bf16 v15, v223, v7, v15
    v_add_f32_dpp v8, v8, v8 row_ror:8 row_mask:0xf bank_mask:0xf
    v_add_f32_dpp v9, v9, v9 row_ror:8 row_mask:0xf bank_mask:0xf
    v_add_f32_dpp v10, v10, v10 row_ror:8 row_mask:0xf bank_mask:0xf
    v_add_f32_dpp v11, v11, v11 row_ror:8 row_mask:0xf bank_mask:0xf
    v_add_f32_dpp v12, v12, v12 row_ror:8 row_mask:0xf bank_mask:0xf
    v_add_f32_dpp v13, v13, v13 row_ror:8 row_mask:0xf bank_mask:0xf
    v_add_f32_dpp v14, v14, v14 row_ror:8 row_mask:0xf bank_mask:0xf
    v_add_f32_dpp v15, v15, v15 row_ror:8 row_mask:0xf bank_mask:0xf
    v_add_f32_dpp v8, v8, v8 row_ror:4 row_mask:0xf bank_mask:0xf
    v_add_f32_dpp v9, v9, v9 row_ror:4 row_mask:0xf bank_mask:0xf
    v_add_f32_dpp v10, v10, v10 row_ror:4 row_mask:0xf bank_mask:0xf
    v_add_f32_dpp v11, v11, v11 row_ror:4 row_mask:0xf bank_mask:0xf
    v_add_f32_dpp v12, v12, v12 row_ror:4 row_mask:0xf bank_mask:0xf
    v_add_f32_dpp v13, v13, v13 row_ror:4 row_mask:0xf bank_mask:0xf
    v_add_f32_dpp v14, v14, v14 row_ror:4 row_mask:0xf bank_mask:0xf
    v_add_f32_dpp v15, v15, v15 row_ror:4 row_mask:0xf bank_mask:0xf
    v_add_f32_dpp v8, v8, v8 row_ror:2 row_mask:0xf bank_mask:0xf
    v_add_f32_dpp v9, v9, v9 row_ror:2 row_mask:0xf bank_mask:0xf
    v_add_f32_dpp v10, v10, v10 row_ror:2 row_mask:0xf bank_mask:0xf
    v_add_f32_dpp v11, v11, v11 row_ror:2 row_mask:0xf bank_mask:0xf
    v_add_f32_dpp v12, v12, v12 row_ror:2 row_mask:0xf bank_mask:0xf
    v_add_f32_dpp v13, v13, v13 row_ror:2 row_mask:0xf bank_mask:0xf
    v_add_f32_dpp v14, v14, v14 row_ror:2 row_mask:0xf bank_mask:0xf
    v_add_f32_dpp v15, v15, v15 row_ror:2 row_mask:0xf bank_mask:0xf
    v_add_f32_dpp v8, v8, v8 row_ror:1 row_mask:0xf bank_mask:0xf
    v_add_f32_dpp v9, v9, v9 row_ror:1 row_mask:0xf bank_mask:0xf
    v_add_f32_dpp v10, v10, v10 row_ror:1 row_mask:0xf bank_mask:0xf
    v_add_f32_dpp v11, v11, v11 row_ror:1 row_mask:0xf bank_mask:0xf
    v_add_f32_dpp v12, v12, v12 row_ror:1 row_mask:0xf bank_mask:0xf
    v_add_f32_dpp v13, v13, v13 row_ror:1 row_mask:0xf bank_mask:0xf
    v_add_f32_dpp v14, v14, v14 row_ror:1 row_mask:0xf bank_mask:0xf
    v_add_f32_dpp v15, v15, v15 row_ror:1 row_mask:0xf bank_mask:0xf
    v_cvt_pk_bf16_f32 v9, v8, v9
    v_cvt_pk_bf16_f32 v11, v10, v11
    v_cvt_pk_bf16_f32 v13, v12, v13
    v_cvt_pk_bf16_f32 v15, v14, v15
    v_lshlrev_b32 v8, 16, v9
    v_and_b32 v9, s52, v9
    v_lshlrev_b32 v10, 16, v11
    v_and_b32 v11, s52, v11
    v_lshlrev_b32 v12, 16, v13
    v_and_b32 v13, s52, v13
    v_lshlrev_b32 v14, 16, v15
    v_and_b32 v15, s52, v15
    v_mul_f32 v8, s58, v8
    v_mul_f32 v9, s58, v9
    v_mul_f32 v10, s58, v10
    v_mul_f32 v11, s58, v11
    v_mul_f32 v12, s58, v12
    v_mul_f32 v13, s58, v13
    v_mul_f32 v14, s58, v14
    v_mul_f32 v15, s58, v15
    v_cvt_pk_bf16_f32 v20, v8, v9
    v_cvt_pk_bf16_f32 v21, v10, v11
    v_cvt_pk_bf16_f32 v22, v12, v13
    v_cvt_pk_bf16_f32 v23, v14, v15
    v_max3_f32 v17, v8, v9, v17
    v_max3_f32 v17, v10, v11, v17
    v_max3_f32 v17, v12, v13, v17
    v_max3_f32 v17, v14, v15, v17
    s_mov_b64 exec, s[64:65]
    ds_write_b128 v118, v[20:23] offset:4096
    s_mov_b64 exec, -1
    v_add_u32 v118, 0x100, v118
L_cl:
    s_cmp_eq_u32 s56, s57
    s_cbranch_scc1 L_event
    v_add_u32 v2, s50, v1
    s_add_u32 s50, s50, 32768
    s_cmp_ge_u32 s50, 163840
    s_cselect_b32 s35, 139264, 0
    s_sub_u32 s50, s50, s35
L_cw:
    ds_read_b64 v[24:25], v3 offset:16
    s_waitcnt lgkmcnt(0)
    v_cmp_lt_i32 vcc, s56, v24
    s_cbranch_vccnz L_go
    v_cmp_ge_i32 vcc, s56, v25
    s_cbranch_vccnz L_finish
    s_sub_u32 s59, s59, 1
    s_cbranch_scc1 L_end
    s_sleep 1
    s_branch L_cw
L_go:
    s_cmp_ge_u32 s56, 244
    s_cbranch_scc1 L_nok
    ds_read_b128 v[32:35], v2 offset:0
    ds_read_b128 v[36:39], v2 offset:1024
    ds_read_b128 v[40:43], v2 offset:2048
    ds_read_b128 v[44:47], v2 offset:3072
    ds_read_b128 v[48:51], v2 offset:4096
    ds_read_b128 v[52:55], v2 offset:5120
    ds_read_b128 v[56:59], v2 offset:6144
    ds_read_b128 v[60:63], v2 offset:7168
    s_add_u32 s56, s56, 4
    v_mov_b32 v26, s56
    s_waitcnt lgkmcnt(4)
    v_dot2_f32_bf16 v8, v32, v4, 0
    v_dot2_f32_bf16 v9, v36, v4, 0
    v_dot2_f32_bf16 v10, v40, v4, 0
    v_dot2_f32_bf16 v11, v44, v4, 0
    v_dot2_f32_bf16 v8, v33, v5, v8
    v_dot2_f32_bf16 v9, v37, v5, v9
    v_dot2_f32_bf16 v10, v41, v5, v10
    v_dot2_f32_bf16 v11, v45, v5, v11
    v_dot2_f32_bf16 v8, v34, v6, v8
    v_dot2_f32_bf16 v9, v38, v6, v9
    v_dot2_f32_bf16 v10, v42, v6, v10
    v_dot2_f32_bf16 v11, v46, v6, v11
    v_dot2_f32_bf16 v8, v35, v7, v8
    v_dot2_f32_bf16 v9, v39, v7, v9
    v_dot2_f32_bf16 v10, v43, v7, v10
    v_dot2_f32_bf16 v11, v47, v7, v11
    s_waitcnt lgkmcnt(0)
    ds_write_b32 v19, v26 offset:32
    v_dot2_f32_bf16 v12, v48, v4, 0
    v_dot2_f32_bf16 v13, v52, v4, 0
    v_dot2_f32_bf16 v14, v56, v4, 0
    v_dot2_f32_bf16 v15, v60, v4, 0
    v_dot2_f32_bf16 v12, v49, v5, v12
    v_dot2_f32_bf16 v13, v53, v5, v13
    v_dot2_f32_bf16 v14, v57, v5, v14
    v_dot2_f32_bf16 v15, v61, v5, v15
    v_dot2_f32_bf16 v12, v50, v6, v12
    v_dot2_f32_bf16 v13, v54, v6, v13
    v_dot2_f32_bf16 v14, v58, v6, v14
    v_dot2_f32_bf16 v15, v62, v6, v15
    v_dot2_f32_bf16 v12, v51, v7, v12
    v_dot2_f32_bf16 v13, v55, v7, v13
    v_dot2_f32_bf16 v14, v59, v7, v14
    v_dot2_f32_bf16 v15, v63, v7, v15
    v_add_f32_dpp v8, v8, v8 row_ror:8 row_mask:0xf bank_mask:0xf
    v_add_f32_dpp v9, v9, v9 row_ror:8 row_mask:0xf bank_mask:0xf
    v_add_f32_dpp v10, v10, v10 row_ror:8 row_mask:0xf bank_mask:0xf
    v_add_f32_dpp v11, v11, v11 row_ror:8 row_mask:0xf bank_mask:0xf
    v_add_f32_dpp v12, v12, v12 row_ror:8 row_mask:0xf bank_mask:0xf
    v_add_f32_dpp v13, v13, v13 row_ror:8 row_mask:0xf bank_mask:0xf
    v_add_f32_dpp v14, v14, v14 row_ror:8 row_mask:0xf bank_mask:0xf
    v_add_f32_dpp v15, v15, v15 row_ror:8 row_mask:0xf bank_mask:0xf
    v_add_f32_dpp v8, v8, v8 row_ror:4 row_mask:0xf bank_mask:0xf
    v_add_f32_dpp v9, v9, v9 row_ror:4 row_mask:0xf bank_mask:0xf
    v_add_f32_dpp v10, v10, v10 row_ror:4 row_mask:0xf bank_mask:0xf
    v_add_f32_dpp v11, v11, v11 row_ror:4 row_mask:0xf bank_mask:0xf
    v_add_f32_dpp v12, v12, v12 row_ror:4 row_mask:0xf bank_mask:0xf
    v_add_f32_dpp v13, v13, v13 row_ror:4 row_mask:0xf bank_mask:0xf
    v_add_f32_dpp v14, v14, v14 row_ror:4 row_mask:0xf bank_mask:0xf
    v_add_f32_dpp v15, v15, v15 row_ror:4 row_mask:0xf bank_mask:0xf
    v_add_f32_dpp v8, v8, v8 row_ror:2 row_mask:0xf bank_mask:0xf
    v_add_f32_dpp v9, v9, v9 row_ror:2 row_mask:0xf bank_mask:0xf
    v_add_f32_dpp v10, v10, v10 row_ror:2 row_mask:0xf bank_mask:0xf
    v_add_f32_dpp v11, v11, v11 row_ror:2 row_mask:0xf bank_mask:0xf
    v_add_f32_dpp v12, v12, v12 row_ror:2 row_mask:0xf bank_mask:0xf
    v_add_f32_dpp v13, v13, v13 row_ror:2 row_mask:0xf bank_mask:0xf
    v_add_f32_dpp v14, v14, v14 row_ror:2 row_mask:0xf bank_mask:0xf
    v_add_f32_dpp v15, v15, v15 row_ror:2 row_mask:0xf bank_mask:0xf
    v_add_f32_dpp v8, v8, v8 row_ror:1 row_mask:0xf bank_mask:0xf
    v_add_f32_dpp v9, v9, v9 row_ror:1 row_mask:0xf bank_mask:0xf
    v_add_f32_dpp v10, v10, v10 row_ror:1 row_mask:0xf bank_mask:0xf
    v_add_f32_dpp v11, v11, v11 row_ror:1 row_mask:0xf bank_mask:0xf
    v_add_f32_dpp v12, v12, v12 row_ror:1 row_mask:0xf bank_mask:0xf
    v_add_f32_dpp v13, v13, v13 row_ror:1 row_mask:0xf bank_mask:0xf
    v_add_f32_dpp v14, v14, v14 row_ror:1 row_mask:0xf bank_mask:0xf
    v_add_f32_dpp v15, v15, v15 row_ror:1 row_mask:0xf bank_mask:0xf
    v_cvt_pk_bf16_f32 v9, v8, v9
    v_cvt_pk_bf16_f32 v11, v10, v11
    v_cvt_pk_bf16_f32 v13, v12, v13
    v_cvt_pk_bf16_f32 v15, v14, v15
    v_lshlrev_b32 v8, 16, v9
    v_and_b32 v9, s52, v9
    v_lshlrev_b32 v10, 16, v11
    v_and_b32 v11, s52, v11
    v_lshlrev_b32 v12, 16, v13
    v_and_b32 v13, s52, v13
    v_lshlrev_b32 v14, 16, v15
    v_and_b32 v15, s52, v15
    v_mul_f32 v8, s58, v8
    v_mul_f32 v9, s58, v9
    v_mul_f32 v10, s58, v10
    v_mul_f32 v11, s58, v11
    v_mul_f32 v12, s58, v12
    v_mul_f32 v13, s58, v13
    v_mul_f32 v14, s58, v14
    v_mul_f32 v15, s58, v15
    v_cvt_pk_bf16_f32 v20, v8, v9
    v_cvt_pk_bf16_f32 v21, v10, v11
    v_cvt_pk_bf16_f32 v22, v12, v13
    v_cvt_pk_bf16_f32 v23, v14, v15
    v_max3_f32 v17, v8, v9, v17
    v_max3_f32 v17, v10, v11, v17
    v_max3_f32 v17, v12, v13, v17
    v_max3_f32 v17, v14, v15, v17
    s_mov_b64 exec, s[64:65]
    ds_write_b128 v118, v[20:23] offset:4096
    s_mov_b64 exec, -1
    v_add_u32 v118, 0x100, v118
    s_cmp_lt_u32 s56, 244
    s_cbranch_scc1 L_cl
    v_cvt_pk_bf16_f32 v17, v17, v17
    v_lshlrev_b32 v17, 16, v17
    v_mov_b32 v8, 0
    v_mov_b32 v9, 0
    v_mov_b32 v10, 0
    v_mov_b32 v11, 0
    v_mov_b32 v12, 0
    v_mov_b32 v13, 0
    v_mov_b32 v14, 0
    v_mov_b32 v15, 0
    v_mul_f32 v18, s55, v17
    v_subrev_u32 v118, 15616, v118
    s_branch L_cl
L_nok:
    s_cmp_ge_u32 s56, 488
    s_cbranch_scc1 L_mix
    ds_read_b128 v[20:23], v118 offset:4096
    ds_read_b128 v[32:35], v2 offset:0
    ds_read_b128 v[36:39], v2 offset:1024
    ds_read_b128 v[40:43], v2 offset:2048
    ds_read_b128 v[44:47], v2 offset:3072
    ds_read_b128 v[48:51], v2 offset:4096
    ds_read_b128 v[52:55], v2 offset:5120
    ds_read_b128 v[56:59], v2 offset:6144
    ds_read_b128 v[60:63], v2 offset:7168
    s_add_u32 s56, s56, 4
    v_mov_b32 v26, s56
    v_add_u32 v118, 0x100, v118
    s_waitcnt lgkmcnt(8)
    v_and_b32 v225, s52, v20
    v_lshlrev_b32 v224, 16, v20
    v_and_b32 v227, s52, v21
    v_lshlrev_b32 v226, 16, v21
    v_and_b32 v229, s52, v22
    v_lshlrev_b32 v228, 16, v22
    v_and_b32 v231, s52, v23
    v_lshlrev_b32 v230, 16, v23
    v_fma_f32 v224, v224, s51, v18
    v_fma_f32 v225, v225, s51, v18
    v_fma_f32 v226, v226, s51, v18
    v_fma_f32 v227, v227, s51, v18
    v_fma_f32 v228, v228, s51, v18
    v_fma_f32 v229, v229, s51, v18
    v_fma_f32 v230, v230, s51, v18
    v_fma_f32 v231, v231, s51, v18
    v_exp_f32 v224, v224
    v_exp_f32 v225, v225
    v_exp_f32 v226, v226
    v_exp_f32 v227, v227
    v_exp_f32 v228, v228
    v_exp_f32 v229, v229
    v_exp_f32 v230, v230
    v_exp_f32 v231, v231
    s_waitcnt lgkmcnt(0)
    ds_write_b32 v19, v26 offset:32
    v_add_f32 v16, v16, v224
    v_add_f32 v16, v16, v225
    v_add_f32 v16, v16, v226
    v_add_f32 v16, v16, v227
    v_add_f32 v16, v16, v228
    v_add_f32 v16, v16, v229
    v_add_f32 v16, v16, v230
    v_add_f32 v16, v16, v231
    v_and_b32 v25, s52, v32
    v_lshlrev_b32 v24, 16, v32
    v_and_b32 v27, s52, v33
    v_lshlrev_b32 v26, 16, v33
    v_and_b32 v29, s52, v34
    v_lshlrev_b32 v28, 16, v34
    v_and_b32 v31, s52, v35
    v_lshlrev_b32 v30, 16, v35
    v_pk_fma_f32 v[8:9], v[24:25], v[224:225], v[8:9] op_sel_hi:[1,0,1]
    v_pk_fma_f32 v[10:11], v[26:27], v[224:225], v[10:11] op_sel_hi:[1,0,1]
    v_pk_fma_f32 v[12:13], v[28:29], v[224:225], v[12:13] op_sel_hi:[1,0,1]
    v_pk_fma_f32 v[14:15], v[30:31], v[224:225], v[14:15] op_sel_hi:[1,0,1]
    v_and_b32 v25, s52, v36
    v_lshlrev_b32 v24, 16, v36
    v_and_b32 v27, s52, v37
    v_lshlrev_b32 v26, 16, v37
    v_and_b32 v29, s52, v38
    v_lshlrev_b32 v28, 16, v38
    v_and_b32 v31, s52, v39
    v_lshlrev_b32 v30, 16, v39
    v_pk_fma_f32 v[8:9], v[24:25], v[224:225], v[8:9] op_sel:[0,1,0] op_sel_hi:[1,1,1]
    v_pk_fma_f32 v[10:11], v[26:27], v[224:225], v[10:11] op_sel:[0,1,0] op_sel_hi:[1,1,1]
    v_pk_fma_f32 v[12:13], v[28:29], v[224:225], v[12:13] op_sel:[0,1,0] op_sel_hi:[1,1,1]
    v_pk_fma_f32 v[14:15], v[30:31], v[224:225], v[14:15] op_sel:[0,1,0] op_sel_hi:[1,1,1]
    v_and_b32 v25, s52, v40
    v_lshlrev_b32 v24, 16, v40
    v_and_b32 v27, s52, v41
    v_lshlrev_b32 v26, 16, v41
    v_and_b32 v29, s52, v42
    v_lshlrev_b32 v28, 16, v42
    v_and_b32 v31, s52, v43
    v_lshlrev_b32 v30, 16, v43
    v_pk_fma_f32 v[8:9], v[24:25], v[226:227], v[8:9] op_sel_hi:[1,0,1]
    v_pk_fma_f32 v[10:11], v[26:27], v[226:227], v[10:11] op_sel_hi:[1,0,1]
    v_pk_fma_f32 v[12:13], v[28:29], v[226:227], v[12:13] op_sel_hi:[1,0,1]
    v_pk_fma_f32 v[14:15], v[30:31], v[226:227], v[14:15] op_sel_hi:[1,0,1]
    v_and_b32 v25, s52, v44
    v_lshlrev_b32 v24, 16, v44
    v_and_b32 v27, s52, v45
    v_lshlrev_b32 v26, 16, v45
    v_and_b32 v29, s52, v46
    v_lshlrev_b32 v28, 16, v46
    v_and_b32 v31, s52, v47
    v_lshlrev_b32 v30, 16, v47
    v_pk_fma_f32 v[8:9], v[24:25], v[226:227], v[8:9] op_sel:[0,1,0] op_sel_hi:[1,1,1]
    v_pk_fma_f32 v[10:11], v[26:27], v[226:227], v[10:11] op_sel:[0,1,0] op_sel_hi:[1,1,1]
    v_pk_fma_f32 v[12:13], v[28:29], v[226:227], v[12:13] op_sel:[0,1,0] op_sel_hi:[1,1,1]
    v_pk_fma_f32 v[14:15], v[30:31], v[226:227], v[14:15] op_sel:[0,1,0] op_sel_hi:[1,1,1]
    v_and_b32 v25, s52, v48
    v_lshlrev_b32 v24, 16, v48
    v_and_b32 v27, s52, v49
    v_lshlrev_b32 v26, 16, v49
    v_and_b32 v29, s52, v50
    v_lshlrev_b32 v28, 16, v50
    v_and_b32 v31, s52, v51
    v_lshlrev_b32 v30, 16, v51
    v_pk_fma_f32 v[8:9], v[24:25], v[228:229], v[8:9] op_sel_hi:[1,0,1]
    v_pk_fma_f32 v[10:11], v[26:27], v[228:229], v[10:11] op_sel_hi:[1,0,1]
    v_pk_fma_f32 v[12:13], v[28:29], v[228:229], v[12:13] op_sel_hi:[1,0,1]
    v_pk_fma_f32 v[14:15], v[30:31], v[228:229], v[14:15] op_sel_hi:[1,0,1]
    v_and_b32 v25, s52, v52
    v_lshlrev_b32 v24, 16, v52
    v_and_b32 v27, s52, v53
    v_lshlrev_b32 v26, 16, v53
    v_and_b32 v29, s52, v54
    v_lshlrev_b32 v28, 16, v54
    v_and_b32 v31, s52, v55
    v_lshlrev_b32 v30, 16, v55
    v_pk_fma_f32 v[8:9], v[24:25], v[228:229], v[8:9] op_sel:[0,1,0] op_sel_hi:[1,1,1]
    v_pk_fma_f32 v[10:11], v[26:27], v[228:229], v[10:11] op_sel:[0,1,0] op_sel_hi:[1,1,1]
    v_pk_fma_f32 v[12:13], v[28:29], v[228:229], v[12:13] op_sel:[0,1,0] op_sel_hi:[1,1,1]
    v_pk_fma_f32 v[14:15], v[30:31], v[228:229], v[14:15] op_sel:[0,1,0] op_sel_hi:[1,1,1]
    v_and_b32 v25, s52, v56
    v_lshlrev_b32 v24, 16, v56
    v_and_b32 v27, s52, v57
    v_lshlrev_b32 v26, 16, v57
    v_and_b32 v29, s52, v58
    v_lshlrev_b32 v28, 16, v58
    v_and_b32 v31, s52, v59
    v_lshlrev_b32 v30, 16, v59
    v_pk_fma_f32 v[8:9], v[24:25], v[230:231], v[8:9] op_sel_hi:[1,0,1]
    v_pk_fma_f32 v[10:11], v[26:27], v[230:231], v[10:11] op_sel_hi:[1,0,1]
    v_pk_fma_f32 v[12:13], v[28:29], v[230:231], v[12:13] op_sel_hi:[1,0,1]
    v_pk_fma_f32 v[14:15], v[30:31], v[230:231], v[14:15] op_sel_hi:[1,0,1]
    v_and_b32 v25, s52, v60
    v_lshlrev_b32 v24, 16, v60
    v_and_b32 v27, s52, v61
    v_lshlrev_b32 v26, 16, v61
    v_and_b32 v29, s52, v62
    v_lshlrev_b32 v28, 16, v62
    v_and_b32 v31, s52, v63
    v_lshlrev_b32 v30, 16, v63
    v_pk_fma_f32 v[8:9], v[24:25], v[230:231], v[8:9] op_sel:[0,1,0] op_sel_hi:[1,1,1]
    v_pk_fma_f32 v[10:11], v[26:27], v[230:231], v[10:11] op_sel:[0,1,0] op_sel_hi:[1,1,1]
    v_pk_fma_f32 v[12:13], v[28:29], v[230:231], v[12:13] op_sel:[0,1,0] op_sel_hi:[1,1,1]
    v_pk_fma_f32 v[14:15], v[30:31], v[230:231], v[14:15] op_sel:[0,1,0] op_sel_hi:[1,1,1]
    s_branch L_cl
L_mix:
    ds_read_b128 v[32:35], v2 offset:0
    ds_read_b128 v[36:39], v2 offset:1024
    ds_read_b128 v[40:43], v2 offset:2048
    ds_read_b128 v[44:47], v2 offset:3072
    ds_read_b128 v[48:51], v2 offset:4096
    ds_read_b128 v[52:55], v2 offset:5120
    ds_read_b128 v[56:59], v2 offset:6144
    ds_read_b128 v[60:63], v2 offset:7168
    s_add_u32 s56, s56, 4
    v_mov_b32 v26, s56
    s_waitcnt lgkmcnt(4)
    v_dot2_f32_bf16 v20, v32, v4, 0
    v_dot2_f32_bf16 v21, v36, v4, 0
    v_dot2_f32_bf16 v22, v40, v4, 0
    v_dot2_f32_bf16 v23, v44, v4, 0
    v_dot2_f32_bf16 v20, v33, v5, v20
    v_dot2_f32_bf16 v21, v37, v5, v21
    v_dot2_f32_bf16 v22, v41, v5, v22
    v_dot2_f32_bf16 v23, v45, v5, v23
    v_dot2_f32_bf16 v20, v34, v6, v20
    v_dot2_f32_bf16 v21, v38, v6, v21
    v_dot2_f32_bf16 v22, v42, v6, v22
    v_dot2_f32_bf16 v23, v46, v6, v23
    v_dot2_f32_bf16 v20, v35, v7, v20
    v_dot2_f32_bf16 v21, v39, v7, v21
    v_dot2_f32_bf16 v22, v43, v7, v22
    v_dot2_f32_bf16 v23, v47, v7, v23
    s_waitcnt lgkmcnt(0)
    ds_write_b32 v19, v26 offset:32
    v_add_f32_dpp v20, v20, v20 row_ror:8 row_mask:0xf bank_mask:0xf
    v_add_f32_dpp v21, v21, v21 row_ror:8 row_mask:0xf bank_mask:0xf
    v_add_f32_dpp v22, v22, v22 row_ror:8 row_mask:0xf bank_mask:0xf
    v_add_f32_dpp v23, v23, v23 row_ror:8 row_mask:0xf bank_mask:0xf
    v_add_f32_dpp v20, v20, v20 row_ror:4 row_mask:0xf bank_mask:0xf
    v_add_f32_dpp v21, v21, v21 row_ror:4 row_mask:0xf bank_mask:0xf
    v_add_f32_dpp v22, v22, v22 row_ror:4 row_mask:0xf bank_mask:0xf
    v_add_f32_dpp v23, v23, v23 row_ror:4 row_mask:0xf bank_mask:0xf
    v_add_f32_dpp v20, v20, v20 row_ror:2 row_mask:0xf bank_mask:0xf
    v_add_f32_dpp v21, v21, v21 row_ror:2 row_mask:0xf bank_mask:0xf
    v_add_f32_dpp v22, v22, v22 row_ror:2 row_mask:0xf bank_mask:0xf
    v_add_f32_dpp v23, v23, v23 row_ror:2 row_mask:0xf bank_mask:0xf
    v_add_f32_dpp v20, v20, v20 row_ror:1 row_mask:0xf bank_mask:0xf
    v_add_f32_dpp v21, v21, v21 row_ror:1 row_mask:0xf bank_mask:0xf
    v_add_f32_dpp v22, v22, v22 row_ror:1 row_mask:0xf bank_mask:0xf
    v_add_f32_dpp v23, v23, v23 row_ror:1 row_mask:0xf bank_mask:0xf
    v_cvt_pk_bf16_f32 v21, v20, v21
    v_cvt_pk_bf16_f32 v23, v22, v23
    v_lshlrev_b32 v20, 16, v21
    v_and_b32 v21, s52, v21
    v_lshlrev_b32 v22, 16, v23
    v_and_b32 v23, s52, v23
    v_mul_f32 v20, s58, v20
    v_mul_f32 v21, s58, v21
    v_mul_f32 v22, s58, v22
    v_mul_f32 v23, s58, v23
    v_cvt_pk_bf16_f32 v21, v20, v21
    v_cvt_pk_bf16_f32 v23, v22, v23
    v_lshlrev_b32 v20, 16, v21
    v_and_b32 v21, s52, v21
    v_lshlrev_b32 v22, 16, v23
    v_and_b32 v23, s52, v23
    v_max3_f32 v24, v20, v21, v22
    v_max3_f32 v24, v24, v23, v17
    v_cmp_gt_f32 vcc, v24, v17
    s_cbranch_vccz L_nors5
    v_mov_b32 v17, v24
    v_mul_f32 v25, s55, v24
    v_sub_f32 v24, v25, v18
    v_exp_f32 v24, v24
    v_mov_b32 v18, v25
    v_pk_mul_f32 v[8:9], v[8:9], v[24:25] op_sel_hi:[1,0]
    v_pk_mul_f32 v[10:11], v[10:11], v[24:25] op_sel_hi:[1,0]
    v_pk_mul_f32 v[12:13], v[12:13], v[24:25] op_sel_hi:[1,0]
    v_pk_mul_f32 v[14:15], v[14:15], v[24:25] op_sel_hi:[1,0]
    v_mul_f32 v16, v16, v24
L_nors5:
    v_fma_f32 v20, v20, s51, v18
    v_fma_f32 v21, v21, s51, v18
    v_fma_f32 v22, v22, s51, v18
    v_fma_f32 v23, v23, s51, v18
    v_exp_f32 v20, v20
    v_exp_f32 v21, v21
    v_exp_f32 v22, v22
    v_exp_f32 v23, v23
    v_add_f32 v16, v16, v20
    v_add_f32 v16, v16, v21
    v_add_f32 v16, v16, v22
    v_add_f32 v16, v16, v23
    v_and_b32 v25, s52, v48
    v_lshlrev_b32 v24, 16, v48
    v_and_b32 v27, s52, v49
    v_lshlrev_b32 v26, 16, v49
    v_and_b32 v29, s52, v50
    v_lshlrev_b32 v28, 16, v50
    v_and_b32 v31, s52, v51
    v_lshlrev_b32 v30, 16, v51
    v_pk_fma_f32 v[8:9], v[24:25], v[20:21], v[8:9] op_sel_hi:[1,0,1]
    v_pk_fma_f32 v[10:11], v[26:27], v[20:21], v[10:11] op_sel_hi:[1,0,1]
    v_pk_fma_f32 v[12:13], v[28:29], v[20:21], v[12:13] op_sel_hi:[1,0,1]
    v_pk_fma_f32 v[14:15], v[30:31], v[20:21], v[14:15] op_sel_hi:[1,0,1]
    v_and_b32 v25, s52, v52
    v_lshlrev_b32 v24, 16, v52
    v_and_b32 v27, s52, v53
    v_lshlrev_b32 v26, 16, v53
    v_and_b32 v29, s52, v54
    v_lshlrev_b32 v28, 16, v54
    v_and_b32 v31, s52, v55
    v_lshlrev_b32 v30, 16, v55
    v_pk_fma_f32 v[8:9], v[24:25], v[20:21], v[8:9] op_sel:[0,1,0] op_sel_hi:[1,1,1]
    v_pk_fma_f32 v[10:11], v[26:27], v[20:21], v[10:11] op_sel:[0,1,0] op_sel_hi:[1,1,1]
    v_pk_fma_f32 v[12:13], v[28:29], v[20:21], v[12:13] op_sel:[0,1,0] op_sel_hi:[1,1,1]
    v_pk_fma_f32 v[14:15], v[30:31], v[20:21], v[14:15] op_sel:[0,1,0] op_sel_hi:[1,1,1]
    v_and_b32 v25, s52, v56
    v_lshlrev_b32 v24, 16, v56
    v_and_b32 v27, s52, v57
    v_lshlrev_b32 v26, 16, v57
    v_and_b32 v29, s52, v58
    v_lshlrev_b32 v28, 16, v58
    v_and_b32 v31, s52, v59
    v_lshlrev_b32 v30, 16, v59
    v_pk_fma_f32 v[8:9], v[24:25], v[22:23], v[8:9] op_sel_hi:[1,0,1]
    v_pk_fma_f32 v[10:11], v[26:27], v[22:23], v[10:11] op_sel_hi:[1,0,1]
    v_pk_fma_f32 v[12:13], v[28:29], v[22:23], v[12:13] op_sel_hi:[1,0,1]
    v_pk_fma_f32 v[14:15], v[30:31], v[22:23], v[14:15] op_sel_hi:[1,0,1]
    v_and_b32 v25, s52, v60
    v_lshlrev_b32 v24, 16, v60
    v_and_b32 v27, s52, v61
    v_lshlrev_b32 v26, 16, v61
    v_and_b32 v29, s52, v62
    v_lshlrev_b32 v28, 16, v62
    v_and_b32 v31, s52, v63
    v_lshlrev_b32 v30, 16, v63
    v_pk_fma_f32 v[8:9], v[24:25], v[22:23], v[8:9] op_sel:[0,1,0] op_sel_hi:[1,1,1]
    v_pk_fma_f32 v[10:11], v[26:27], v[22:23], v[10:11] op_sel:[0,1,0] op_sel_hi:[1,1,1]
    v_pk_fma_f32 v[12:13], v[28:29], v[22:23], v[12:13] op_sel:[0,1,0] op_sel_hi:[1,1,1]
    v_pk_fma_f32 v[14:15], v[30:31], v[22:23], v[14:15] op_sel:[0,1,0] op_sel_hi:[1,1,1]
    s_branch L_cl
L_event:
    s_add_u32 s57, s57, 8
    s_add_u32 s92, s92, 1
    s_cmp_eq_u32 s92, 2
    s_cbranch_scc1 L_ev2
    s_cmp_eq_u32 s92, 3
    s_cbranch_scc1 L_ev3
    s_cmp_eq_u32 s92, 4
    s_cbranch_scc1 L_ev4
    s_cmp_lt_u32 s69, 4
    s_cbranch_scc1 L_ldwo
    s_cmp_ge_u32 s68, 56
    s_cbranch_scc1 L_cl
    s_movk_i32 s35, 3584
    v_mul_lo_u32 v70, s35, v65
    s_lshl_b32 s35, s68, 6
    v_add3_u32 v70, v70, v66, s35
    s_mov_b32 s40, s16
    s_mov_b32 s41, s17
    s_mov_b32 s42, 1835008
    s_mov_b32 s43, 0x20000
    buffer_load_dwordx4 v[128:131], v70, s[40:43], 0 offen nt
    s_mov_b32 s48, 3584
    buffer_load_dwordx4 v[132:135], v70, s[40:43], s48 offen nt
    s_mov_b32 s48, 7168
    buffer_load_dwordx4 v[136:139], v70, s[40:43], s48 offen nt
    s_mov_b32 s48, 10752
    buffer_load_dwordx4 v[140:143], v70, s[40:43], s48 offen nt
    s_mov_b32 s48, 14336
    buffer_load_dwordx4 v[144:147], v70, s[40:43], s48 offen nt
    s_mov_b32 s48, 17920
    buffer_load_dwordx4 v[148:151], v70, s[40:43], s48 offen nt
    s_mov_b32 s48, 21504
    buffer_load_dwordx4 v[152:155], v70, s[40:43], s48 offen nt
    s_mov_b32 s48, 25088
    buffer_load_dwordx4 v[156:159], v70, s[40:43], s48 offen nt
    s_branch L_cl
L_ldwo:
    s_lshr_b32 s35, s34, 4
    s_lshl_b32 s35, s35, 19
    s_add_u32 s40, s12, s35
    s_addc_u32 s41, s13, 0
    s_mov_b32 s42, 524288
    s_mov_b32 s43, 0x20000
    s_and_b32 s35, s49, 0x3ff
    v_lshlrev_b32 v70, 10, v65
    v_add3_u32 v70, v70, v66, s35
    buffer_load_dwordx4 v[128:131], v70, s[40:43], 0 offen nt
    s_mov_b32 s48, 1024
    buffer_load_dwordx4 v[132:135], v70, s[40:43], s48 offen nt
    s_mov_b32 s48, 2048
    buffer_load_dwordx4 v[136:139], v70, s[40:43], s48 offen nt
    s_mov_b32 s48, 3072
    buffer_load_dwordx4 v[140:143], v70, s[40:43], s48 offen nt
    s_mov_b32 s48, 4096
    buffer_load_dwordx4 v[144:147], v70, s[40:43], s48 offen nt
    s_mov_b32 s48, 5120
    buffer_load_dwordx4 v[148:151], v70, s[40:43], s48 offen nt
    s_mov_b32 s48, 6144
    buffer_load_dwordx4 v[152:155], v70, s[40:43], s48 offen nt
    s_mov_b32 s48, 7168
    buffer_load_dwordx4 v[156:159], v70, s[40:43], s48 offen nt
    s_branch L_cl
L_ev2:
    s_waitcnt vmcnt(0)
    v_perm_b32 v127, v132, v128, s53
    v_perm_b32 v132, v132, v128, s54
    v_perm_b32 v128, v133, v129, s53
    v_perm_b32 v133, v133, v129, s54
    v_perm_b32 v129, v134, v130, s53
    v_perm_b32 v134, v134, v130, s54
    v_perm_b32 v130, v135, v131, s53
    v_perm_b32 v135, v135, v131, s54
    v_perm_b32 v131, v140, v136, s53
    v_perm_b32 v140, v140, v136, s54
    v_perm_b32 v136, v141, v137, s53
    v_perm_b32 v141, v141, v137, s54
    v_perm_b32 v137, v142, v138, s53
    v_perm_b32 v142, v142, v138, s54
    v_perm_b32 v138, v143, v139, s53
    v_perm_b32 v143, v143, v139, s54
    v_perm_b32 v139, v148, v144, s53
    v_perm_b32 v148, v148, v144, s54
    v_perm_b32 v144, v149, v145, s53
    v_perm_b32 v149, v149, v145, s54
    v_perm_b32 v145, v150, v146, s53
    v_perm_b32 v150, v150, v146, s54
    v_perm_b32 v146, v151, v147, s53
    v_perm_b32 v151, v151, v147, s54
    v_perm_b32 v147, v156, v152, s53
    v_perm_b32 v156, v156, v152, s54
    v_perm_b32 v152, v157, v153, s53
    v_perm_b32 v157, v157, v153, s54
    v_perm_b32 v153, v158, v154, s53
    v_perm_b32 v158, v158, v154, s54
    v_perm_b32 v154, v159, v155, s53
    v_perm_b32 v159, v159, v155, s54
    s_cmp_ge_u32 s68, 56
    s_cbranch_scc1 L_cl
    s_mov_b32 s40, s18
    s_mov_b32 s41, s19
    s_mov_b32 s42, 1835008
    s_mov_b32 s43, 0x20000
    buffer_load_dwordx4 v[160:163], v70, s[40:43], 0 offen nt
    s_mov_b32 s48, 3584
    buffer_load_dwordx4 v[164:167], v70, s[40:43], s48 offen nt
    s_mov_b32 s48, 7168
    buffer_load_dwordx4 v[168:171], v70, s[40:43], s48 offen nt
    s_mov_b32 s48, 10752
    buffer_load_dwordx4 v[172:175], v70, s[40:43], s48 offen nt
    s_mov_b32 s48, 14336
    buffer_load_dwordx4 v[176:179], v70, s[40:43], s48 offen nt
    s_mov_b32 s48, 17920
    buffer_load_dwordx4 v[180:183], v70, s[40:43], s48 offen nt
    s_mov_b32 s48, 21504
    buffer_load_dwordx4 v[184:187], v70, s[40:43], s48 offen nt
    s_mov_b32 s48, 25088
    buffer_load_dwordx4 v[188:191], v70, s[40:43], s48 offen nt
    s_branch L_cl
L_ev3:
    s_cmp_ge_u32 s68, 56
    s_cbranch_scc1 L_cl
    s_waitcnt vmcnt(0)
    v_perm_b32 v126, v164, v160, s53
    v_perm_b32 v164, v164, v160, s54
    v_perm_b32 v160, v165, v161, s53
    v_perm_b32 v165, v165, v161, s54
    v_perm_b32 v161, v166, v162, s53
    v_perm_b32 v166, v166, v162, s54
    v_perm_b32 v162, v167, v163, s53
    v_perm_b32 v167, v167, v163, s54
    v_perm_b32 v163, v172, v168, s53
    v_perm_b32 v172, v172, v168, s54
    v_perm_b32 v168, v173, v169, s53
    v_perm_b32 v173, v173, v169, s54
    v_perm_b32 v169, v174, v170, s53
    v_perm_b32 v174, v174, v170, s54
    v_perm_b32 v170, v175, v171, s53
    v_perm_b32 v175, v175, v171, s54
    v_perm_b32 v171, v180, v176, s53
    v_perm_b32 v180, v180, v176, s54
    v_perm_b32 v176, v181, v177, s53
    v_perm_b32 v181, v181, v177, s54
    v_perm_b32 v177, v182, v178, s53
    v_perm_b32 v182, v182, v178, s54
    v_perm_b32 v178, v183, v179, s53
    v_perm_b32 v183, v183, v179, s54
    v_perm_b32 v179, v188, v184, s53
    v_perm_b32 v188, v188, v184, s54
    v_perm_b32 v184, v189, v185, s53
    v_perm_b32 v189, v189, v185, s54
    v_perm_b32 v185, v190, v186, s53
    v_perm_b32 v190, v190, v186, s54
    v_perm_b32 v186, v191, v187, s53
    v_perm_b32 v191, v191, v187, s54
    s_lshl_b32 s35, s68, 15
    s_add_u32 s40, s20, s35
    s_addc_u32 s41, s21, 0
    s_mov_b32 s42, 32768
    s_mov_b32 s43, 0x20000
    v_lshrrev_b32 v70, 4, v0
    v_lshlrev_b32 v70, 13, v70
    v_and_b32 v71, 15, v0
    v_lshl_add_u32 v70, v71, 4, v70
    s_lshl_b32 s35, s33, 8
    v_add_u32 v70, s35, v70
    buffer_load_dwordx4 v[192:195], v70, s[40:43], 0 offen nt
    s_mov_b32 s48, 1024
    buffer_load_dwordx4 v[196:199], v70, s[40:43], s48 offen nt
    s_mov_b32 s48, 2048
    buffer_load_dwordx4 v[200:203], v70, s[40:43], s48 offen nt
    s_mov_b32 s48, 3072
    buffer_load_dwordx4 v[204:207], v70, s[40:43], s48 offen nt
    s_mov_b32 s48, 4096
    buffer_load_dwordx4 v[208:211], v70, s[40:43], s48 offen nt
    s_mov_b32 s48, 5120
    buffer_load_dwordx4 v[212:215], v70, s[40:43], s48 offen nt
    s_mov_b32 s48, 6144
    buffer_load_dwordx4 v[216:219], v70, s[40:43], s48 offen nt
    s_mov_b32 s48, 7168
    buffer_load_dwordx4 v[220:223], v70, s[40:43], s48 offen nt
    s_branch L_cl
L_ev4:
    s_mov_b32 s57, -1
    s_cmp_ge_u32 s68, 56
    s_cbranch_scc1 L_dry
    s_waitcnt vmcnt(0)
    v_perm_b32 v125, v196, v192, s53
    v_perm_b32 v196, v196, v192, s54
    v_perm_b32 v192, v197, v193, s53
    v_perm_b32 v197, v197, v193, s54
    v_perm_b32 v193, v198, v194, s53
    v_perm_b32 v198, v198, v194, s54
    v_perm_b32 v194, v199, v195, s53
    v_perm_b32 v199, v199, v195, s54
    v_perm_b32 v195, v204, v200, s53
    v_perm_b32 v204, v204, v200, s54
    v_perm_b32 v200, v205, v201, s53
    v_perm_b32 v205, v205, v201, s54
    v_perm_b32 v201, v206, v202, s53
    v_perm_b32 v206, v206, v202, s54
    v_perm_b32 v202, v207, v203, s53
    v_perm_b32 v207, v207, v203, s54
    v_perm_b32 v203, v212, v208, s53
    v_perm_b32 v212, v212, v208, s54
    v_perm_b32 v208, v213, v209, s53
    v_perm_b32 v213, v213, v209, s54
    v_perm_b32 v209, v214, v210, s53
    v_perm_b32 v214, v214, v210, s54
    v_perm_b32 v210, v215, v211, s53
    v_perm_b32 v215, v215, v211, s54
    v_perm_b32 v211, v220, v216, s53
    v_perm_b32 v220, v220, v216, s54
    v_perm_b32 v216, v221, v217, s53
    v_perm_b32 v221, v221, v217, s54
    v_perm_b32 v217, v222, v218, s53
    v_perm_b32 v222, v222, v218, s54
    v_perm_b32 v218, v223, v219, s53
    v_perm_b32 v223, v223, v219, s54
    global_load_dword v76, v111, s[4:5]
    s_lshl_b32 s35, s68, 2
    s_add_u32 s35, s35, s33
    s_lshl_b32 s90, s35, 4
    s_lshl_b32 s35, s35, 2
    v_lshrrev_b32 v116, 4, v0
    v_add_u32 v116, s35, v116
    v_and_b32 v116, 0x1ff, v116
    v_lshrrev_b32 v117, 1, v116
    v_lshlrev_b32 v117, 3, v117
L_poll6:
    s_mov_b32 s48, 8192
    buffer_load_dwordx2 v[84:85], v110, s[36:39], s48 offen sc1
    buffer_load_dwordx2 v[86:87], v110, s[36:39], s48 offen offset:2048 sc1
    s_mov_b32 s48, 12288
    buffer_load_dwordx2 v[88:89], v110, s[36:39], s48 offen sc1
    s_mov_b32 s48, 14336
    buffer_load_dwordx2 v[108:109], v117, s[36:39], s48 offen sc1
    s_waitcnt vmcnt(0)
    v_xor_b32 v100, s32, v85
    v_xor_b32 v87, s32, v87
    v_xor_b32 v89, s32, v89
    v_xor_b32 v109, s32, v109
    v_or3_b32 v100, v100, v87, v89
    v_or_b32 v100, v100, v109
    v_cmp_ne_u32 vcc, 0, v100
    s_cbranch_vccz L_pdone7
    s_mov_b64 exec, vcc
    s_sub_u32 s59, s59, 1
    s_cbranch_scc1 L_end
    s_sleep 8
    s_branch L_poll6
L_pdone7:
    s_mov_b64 exec, s[66:67]
    v_and_b32 v85, s52, v84
    v_lshlrev_b32 v84, 16, v84
    v_and_b32 v87, s52, v86
    v_lshlrev_b32 v86, 16, v86
    v_and_b32 v89, s52, v88
    v_lshlrev_b32 v88, 16, v88
    v_and_b32 v77, s52, v76
    v_lshlrev_b32 v76, 16, v76
    v_add_f32 v88, 1.0, v88
    v_add_f32 v89, 1.0, v89
    v_cvt_pk_bf16_f32 v89, v88, v89
    v_lshlrev_b32 v88, 16, v89
    v_and_b32 v89, s52, v89
    v_lshlrev_b32 v109, 16, v108
    v_and_b32 v108, s52, v108
    v_and_b32 v117, 1, v116
    v_cmp_eq_u32 vcc, 1, v117
    s_nop 1
    v_cndmask_b32 v108, v109, v108, vcc
    v_lshlrev_b32 v116, 1, v116
L_dry:
    s_branch L_cl
L_finish:
    v_mov_b32 v26, v18
    v_mov_b32 v24, v26
    s_nop 1
    v_permlane32_swap_b32 v26, v24
    v_min_f32 v26, v26, v24
    v_mov_b32 v24, v26
    s_nop 1
    v_permlane16_swap_b32 v26, v24
    v_min_f32 v26, v26, v24
    v_sub_f32 v24, v26, v18
    v_exp_f32 v24, v24
    v_mov_b32 v23, 1
    v_lshl_add_u32 v28, v19, 7, v115
    v_pk_mul_f32 v[8:9], v[8:9], v[24:25] op_sel_hi:[1,0]
    v_pk_mul_f32 v[10:11], v[10:11], v[24:25] op_sel_hi:[1,0]
    v_pk_mul_f32 v[12:13], v[12:13], v[24:25] op_sel_hi:[1,0]
    v_pk_mul_f32 v[14:15], v[14:15], v[24:25] op_sel_hi:[1,0]
    v_mul_f32 v27, v16, v24
    v_lshlrev_b32 v29, 1, v19
    v_permlane32_swap_b32 v8, v12
    v_permlane32_swap_b32 v9, v13
    v_permlane32_swap_b32 v10, v14
    v_permlane32_swap_b32 v11, v15
    v_add_f32 v8, v8, v12
    v_add_f32 v9, v9, v13
    v_add_f32 v10, v10, v14
    v_add_f32 v11, v11, v15
    s_nop 0
    v_permlane16_swap_b32 v8, v10
    v_permlane16_swap_b32 v9, v11
    v_add_f32 v8, v8, v10
    v_add_f32 v9, v9, v11
    v_mov_b32 v24, v27
    s_nop 1
    v_permlane32_swap_b32 v27, v24
    v_add_f32 v27, v27, v24
    v_mov_b32 v24, v27
    s_nop 1
    v_permlane16_swap_b32 v27, v24
    v_add_f32 v27, v27, v24
    ds_write_b64 v28, v[8:9] offset:4096
    ds_write_b64 v29, v[26:27] offset:3072
    s_and_b64 exec, 1, s[66:67]
    ds_add_rtn_u32 v22, v3, v23 offset:4
    s_mov_b64 exec, s[66:67]
    ds_read_b128 v[32:35], v3 offset:3072
    ds_read_b128 v[36:39], v3 offset:3088
    ds_read_b64 v[48:49], v119 offset:4096
    ds_read_b64 v[50:51], v119 offset:4608
    ds_read_b64 v[52:53], v119 offset:5120
    ds_read_b64 v[54:55], v119 offset:5632
    s_waitcnt lgkmcnt(6)
    v_readfirstlane_b32 s35, v22
    s_xor_b32 s35, s35, 3
    s_and_b32 s35, s35, s66
    s_cbranch_scc1 L_notlast
    s_lshl_b32 s48, s2, 10
    s_add_u32 s48, s48, 65536
    s_waitcnt lgkmcnt(4)
    v_min3_f32 v26, v32, v34, v36
    v_min_f32 v26, v26, v38
    v_sub_f32 v32, v26, v32
    v_sub_f32 v34, v26, v34
    v_sub_f32 v36, v26, v36
    v_sub_f32 v38, v26, v38
    v_exp_f32 v32, v32
    v_exp_f32 v34, v34
    v_exp_f32 v36, v36
    v_exp_f32 v38, v38
    s_waitcnt lgkmcnt(0)
    v_mul_f32 v27, v32, v33
    v_pk_mul_f32 v[28:29], v[48:49], v[32:33] op_sel_hi:[1,0]
    v_fmac_f32 v27, v34, v35
    v_pk_fma_f32 v[28:29], v[50:51], v[34:35], v[28:29] op_sel_hi:[1,0,1]
    v_fmac_f32 v27, v36, v37
    v_pk_fma_f32 v[28:29], v[52:53], v[36:37], v[28:29] op_sel_hi:[1,0,1]
    v_fmac_f32 v27, v38, v39
    v_pk_fma_f32 v[28:29], v[54:55], v[38:39], v[28:29] op_sel_hi:[1,0,1]
    v_min_u32 v28, -2, v28
    v_min_u32 v29, -2, v29
    v_min_u32 v26, -2, v26
    v_min_u32 v27, -2, v27
    buffer_store_dwordx2 v[28:29], v119, s[36:39], s48 offen sc1
    s_and_b64 exec, 1, s[66:67]
    buffer_store_dwordx2 v[26:27], off, s[36:39], s48 offset:512 sc1
    s_mov_b64 exec, s[66:67]
L_notlast:
    s_waitcnt lgkmcnt(0)
    s_cmp_lt_u32 s68, 56
    s_cbranch_scc1 L_ffn
    s_cmp_ge_u32 s69, 4
    s_cbranch_scc1 L_end
    s_lshr_b32 s35, s34, 4
    s_lshl_b32 s35, s35, 2
    s_add_u32 s35, s35, s33
    s_lshl_b32 s35, s35, 13
    s_add_u32 s48, s35, 65536
    v_lshlrev_b32 v30, 7, v66
    v_and_b32 v31, 0x1ff, v68
    v_add_u32 v31, v31, v30
L_poll8:
    buffer_load_dwordx2 v[240:241], v30, s[36:39], s48 offen offset:512 sc1
    buffer_load_dwordx4 v[224:227], v31, s[36:39], s48 offen offset:0 sc1
    buffer_load_dwordx4 v[228:231], v31, s[36:39], s48 offen offset:16 sc1
    buffer_load_dwordx2 v[242:243], v30, s[36:39], s48 offen offset:1536 sc1
    buffer_load_dwordx4 v[232:235], v31, s[36:39], s48 offen offset:1024 sc1
    buffer_load_dwordx4 v[236:239], v31, s[36:39], s48 offen offset:1040 sc1
    s_waitcnt vmcnt(0)
    v_max_u32 v24, v224, v225
    v_max3_u32 v24, v24, v226, v227
    v_max3_u32 v24, v24, v228, v229
    v_max3_u32 v24, v24, v230, v231
    v_max3_u32 v24, v24, v232, v233
    v_max3_u32 v24, v24, v234, v235
    v_max3_u32 v24, v24, v236, v237
    v_max3_u32 v24, v24, v238, v239
    v_max3_u32 v24, v24, v240, v241
    v_max3_u32 v24, v24, v242, v243
    v_cmp_eq_u32 vcc, -1, v24
    s_cbranch_vccz L_pdone9
    s_mov_b64 exec, vcc
    s_sub_u32 s59, s59, 1
    s_cbranch_scc1 L_end
    s_branch L_poll8
L_pdone9:
    s_mov_b64 exec, s[66:67]
    v_min_f32 v24, v240, v242
    s_nop 1
    v_min_f32_dpp v24, v24, v24 quad_perm:[1,0,3,2] row_mask:0xf bank_mask:0xf
    s_nop 1
    v_min_f32_dpp v24, v24, v24 quad_perm:[2,3,0,1] row_mask:0xf bank_mask:0xf
    v_sub_f32 v48, v24, v240
    v_sub_f32 v50, v24, v242
    v_exp_f32 v48, v48
    v_exp_f32 v50, v50
    v_mul_f32 v24, v48, v241
    v_fmac_f32 v24, v50, v243
    v_pk_mul_f32 v[32:33], v[224:225], v[48:49] op_sel_hi:[1,0]
    v_pk_mul_f32 v[34:35], v[226:227], v[48:49] op_sel_hi:[1,0]
    v_pk_mul_f32 v[36:37], v[228:229], v[48:49] op_sel_hi:[1,0]
    v_pk_mul_f32 v[38:39], v[230:231], v[48:49] op_sel_hi:[1,0]
    v_pk_fma_f32 v[32:33], v[232:233], v[50:51], v[32:33] op_sel_hi:[1,0,1]
    v_pk_fma_f32 v[34:35], v[234:235], v[50:51], v[34:35] op_sel_hi:[1,0,1]
    v_pk_fma_f32 v[36:37], v[236:237], v[50:51], v[36:37] op_sel_hi:[1,0,1]
    v_pk_fma_f32 v[38:39], v[238:239], v[50:51], v[38:39] op_sel_hi:[1,0,1]
    v_add_f32_dpp v24, v24, v24 quad_perm:[1,0,3,2] row_mask:0xf bank_mask:0xf
    v_add_f32_dpp v32, v32, v32 quad_perm:[1,0,3,2] row_mask:0xf bank_mask:0xf
    v_add_f32_dpp v33, v33, v33 quad_perm:[1,0,3,2] row_mask:0xf bank_mask:0xf
    v_add_f32_dpp v34, v34, v34 quad_perm:[1,0,3,2] row_mask:0xf bank_mask:0xf
    v_add_f32_dpp v35, v35, v35 quad_perm:[1,0,3,2] row_mask:0xf bank_mask:0xf
    v_add_f32_dpp v36, v36, v36 quad_perm:[1,0,3,2] row_mask:0xf bank_mask:0xf
    v_add_f32_dpp v37, v37, v37 quad_perm:[1,0,3,2] row_mask:0xf bank_mask:0xf
    v_add_f32_dpp v38, v38, v38 quad_perm:[1,0,3,2] row_mask:0xf bank_mask:0xf
    v_add_f32_dpp v39, v39, v39 quad_perm:[1,0,3,2] row_mask:0xf bank_mask:0xf
    v_add_f32_dpp v24, v24, v24 quad_perm:[2,3,0,1] row_mask:0xf bank_mask:0xf
    v_add_f32_dpp v32, v32, v32 quad_perm:[2,3,0,1] row_mask:0xf bank_mask:0xf
    v_add_f32_dpp v33, v33, v33 quad_perm:[2,3,0,1] row_mask:0xf bank_mask:0xf
    v_add_f32_dpp v34, v34, v34 quad_perm:[2,3,0,1] row_mask:0xf bank_mask:0xf
    v_add_f32_dpp v35, v35, v35 quad_perm:[2,3,0,1] row_mask:0xf bank_mask:0xf
    v_add_f32_dpp v36, v36, v36 quad_perm:[2,3,0,1] row_mask:0xf bank_mask:0xf
    v_add_f32_dpp v37, v37, v37 quad_perm:[2,3,0,1] row_mask:0xf bank_mask:0xf
    v_add_f32_dpp v38, v38, v38 quad_perm:[2,3,0,1] row_mask:0xf bank_mask:0xf
    v_add_f32_dpp v39, v39, v39 quad_perm:[2,3,0,1] row_mask:0xf bank_mask:0xf
    v_rcp_f32 v24, v24
    s_nop 0
    v_pk_mul_f32 v[32:33], v[32:33], v[24:25] op_sel_hi:[1,0]
    v_pk_mul_f32 v[34:35], v[34:35], v[24:25] op_sel_hi:[1,0]
    v_pk_mul_f32 v[36:37], v[36:37], v[24:25] op_sel_hi:[1,0]
    v_pk_mul_f32 v[38:39], v[38:39], v[24:25] op_sel_hi:[1,0]
    v_cvt_pk_bf16_f32 v72, v32, v33
    v_cvt_pk_bf16_f32 v73, v34, v35
    v_cvt_pk_bf16_f32 v74, v36, v37
    v_cvt_pk_bf16_f32 v75, v38, v39
    v_dot2_f32_bf16 v8, v127, v72, 0
    v_dot2_f32_bf16 v9, v132, v72, 0
    v_dot2_f32_bf16 v10, v128, v72, 0
    v_dot2_f32_bf16 v11, v133, v72, 0
    v_dot2_f32_bf16 v12, v129, v72, 0
    v_dot2_f32_bf16 v13, v134, v72, 0
    v_dot2_f32_bf16 v14, v130, v72, 0
    v_dot2_f32_bf16 v15, v135, v72, 0
    v_dot2_f32_bf16 v8, v131, v73, v8
    v_dot2_f32_bf16 v9, v140, v73, v9
    v_dot2_f32_bf16 v10, v136, v73, v10
    v_dot2_f32_bf16 v11, v141, v73, v11
    v_dot2_f32_bf16 v12, v137, v73, v12
    v_dot2_f32_bf16 v13, v142, v73, v13
    v_dot2_f32_bf16 v14, v138, v73, v14
    v_dot2_f32_bf16 v15, v143, v73, v15
    v_dot2_f32_bf16 v8, v139, v74, v8
    v_dot2_f32_bf16 v9, v148, v74, v9
    v_dot2_f32_bf16 v10, v144, v74, v10
    v_dot2_f32_bf16 v11, v149, v74, v11
    v_dot2_f32_bf16 v12, v145, v74, v12
    v_dot2_f32_bf16 v13, v150, v74, v13
    v_dot2_f32_bf16 v14, v146, v74, v14
    v_dot2_f32_bf16 v15, v151, v74, v15
    v_dot2_f32_bf16 v8, v147, v75, v8
    v_dot2_f32_bf16 v9, v156, v75, v9
    v_dot2_f32_bf16 v10, v152, v75, v10
    v_dot2_f32_bf16 v11, v157, v75, v11
    v_dot2_f32_bf16 v12, v153, v75, v12
    v_dot2_f32_bf16 v13, v158, v75, v13
    v_dot2_f32_bf16 v14, v154, v75, v14
    v_dot2_f32_bf16 v15, v159, v75, v15
    v_and_b32 v24, 15, v0
    v_lshlrev_b32 v24, 3, v24
    v_mov_b32 v23, 1
    v_permlane32_swap_b32 v8, v12
    v_permlane32_swap_b32 v9, v13
    v_permlane32_swap_b32 v10, v14
    v_permlane32_swap_b32 v11, v15
    v_add_f32 v8, v8, v12
    v_add_f32 v9, v9, v13
    v_add_f32 v10, v10, v14
    v_add_f32 v11, v11, v15
    s_nop 0
    v_permlane16_swap_b32 v8, v10
    v_permlane16_swap_b32 v9, v11
    v_add_f32 v8, v8, v10
    v_add_f32 v9, v9, v11
    s_nop 0
    v_add_f32_dpp v8, v8, v8 row_ror:8 row_mask:0xf bank_mask:0xf
    v_add_f32_dpp v9, v9, v9 row_ror:8 row_mask:0xf bank_mask:0xf
    s_nop 0
    v_add_f32_dpp v8, v8, v8 row_ror:4 row_mask:0xf bank_mask:0xf
    v_add_f32_dpp v9, v9, v9 row_ror:4 row_mask:0xf bank_mask:0xf
    ds_write_b64 v67, v[8:9] offset:512
    s_and_b64 exec, 1, s[66:67]
    ds_add_rtn_u32 v22, v3, v23 offset:8
    s_mov_b64 exec, s[66:67]
    ds_read_b64 v[26:27], v24 offset:512
    ds_read_b64 v[28:29], v24 offset:640
    ds_read_b64 v[30:31], v24 offset:768
    ds_read_b64 v[32:33], v24 offset:896
    s_waitcnt lgkmcnt(4)
    v_readfirstlane_b32 s35, v22
    s_xor_b32 s35, s35, 3
    s_and_b32 s35, s35, s66
    s_cbranch_scc1 L_end
    s_waitcnt lgkmcnt(0)
    v_pk_add_f32 v[26:27], v[26:27], v[28:29]
    v_pk_add_f32 v[30:31], v[30:31], v[32:33]
    v_pk_add_f32 v[26:27], v[26:27], v[30:31]
    v_min_u32 v26, -2, v26
    v_min_u32 v27, -2, v27
    s_lshl_b32 s48, s34, 7
    s_add_u32 s48, s48, 327680
    s_and_b64 exec, 0xffff, s[66:67]
    buffer_store_dwordx2 v[26:27], v120, s[36:39], s48 offen sc1
    s_branch L_end
L_ffn:
    s_mov_b32 s48, 327680
    v_lshl_add_u32 v31, v66, 8, v68
    s_and_b64 exec, 15, s[66:67]
L_pa:
    buffer_load_dword v32, v31, s[36:39], s48 offen sc1
    s_sub_u32 s59, s59, 1
    s_cbranch_scc1 L_end
    s_waitcnt vmcnt(0)
    v_cmp_ne_u32 vcc, -1, v32
    s_cbranch_vccnz L_pad
    s_cbranch_execz L_pad
    s_sleep 2
    s_branch L_pa
L_pad:
    s_mov_b64 exec, s[66:67]
    s_add_u32 s44, s48, 0
    s_add_u32 s45, s48, 4096
    s_add_u32 s46, s48, 8192
    s_add_u32 s47, s48, 12288
    s_lshl_b32 s48, s68, 11
    s_lshl_b32 s35, s33, 9
    s_add_u32 s48, s48, s35
    s_add_u32 s48, s48, 344064
    v_lshlrev_b32 v31, 11, v0
L_poll10:
    buffer_load_dwordx2 v[224:225], v110, s[36:39], s44 offen offset:0 sc1
    buffer_load_dwordx2 v[226:227], v110, s[36:39], s44 offen offset:2048 sc1
    buffer_load_dwordx2 v[228:229], v110, s[36:39], s45 offen offset:0 sc1
    buffer_load_dwordx2 v[230:231], v110, s[36:39], s45 offen offset:2048 sc1
    buffer_load_dwordx2 v[232:233], v110, s[36:39], s46 offen offset:0 sc1
    buffer_load_dwordx2 v[234:235], v110, s[36:39], s46 offen offset:2048 sc1
    buffer_load_dwordx2 v[236:237], v110, s[36:39], s47 offen offset:0 sc1
    buffer_load_dwordx2 v[238:239], v110, s[36:39], s47 offen offset:2048 sc1
    s_waitcnt vmcnt(0)
    v_max_u32 v24, v224, v225
    v_max3_u32 v24, v24, v226, v227
    v_max3_u32 v24, v24, v228, v229
    v_max3_u32 v24, v24, v230, v231
    v_max3_u32 v24, v24, v232, v233
    v_max3_u32 v24, v24, v234, v235
    v_max3_u32 v24, v24, v236, v237
    v_max3_u32 v24, v24, v238, v239
    v_cmp_eq_u32 vcc, -1, v24
    s_cbranch_vccz L_pdone11
    s_mov_b64 exec, vcc
    s_sub_u32 s59, s59, 1
    s_cbranch_scc1 L_end
    s_branch L_poll10
L_pdone11:
    s_mov_b64 exec, s[66:67]
    v_pk_add_f32 v[224:225], v[224:225], v[226:227]
    v_pk_add_f32 v[228:229], v[228:229], v[230:231]
    v_pk_add_f32 v[232:233], v[232:233], v[234:235]
    v_pk_add_f32 v[236:237], v[236:237], v[238:239]
    v_pk_add_f32 v[224:225], v[224:225], v[228:229]
    v_pk_add_f32 v[232:233], v[232:233], v[236:237]
    v_pk_add_f32 v[32:33], v[224:225], v[232:233]
    v_cvt_pk_bf16_f32 v33, v32, v33
    v_lshlrev_b32 v32, 16, v33
    v_and_b32 v33, s52, v33
    v_pk_mul_f32 v[32:33], v[32:33], v[84:85]
    v_cvt_pk_bf16_f32 v33, v32, v33
    v_lshlrev_b32 v32, 16, v33
    v_and_b32 v33, s52, v33
    v_pk_add_f32 v[32:33], v[32:33], v[76:77]
    v_cvt_pk_bf16_f32 v77, v32, v33
    ds_write_b32 v111, v77 offset:1536
    s_waitcnt lgkmcnt(0)
    s_cbranch_execz L_nb1
    s_barrier
L_nb1:
    ds_read_b128 v[32:35], v1 offset:1536
    ds_read_u16 v109, v116 offset:1536
    v_lshlrev_b32 v76, 16, v77
    v_and_b32 v77, s52, v77
    s_waitcnt lgkmcnt(1)
    v_and_b32 v37, s52, v32
    v_lshlrev_b32 v36, 16, v32
    v_and_b32 v39, s52, v33
    v_lshlrev_b32 v38, 16, v33
    v_and_b32 v41, s52, v34
    v_lshlrev_b32 v40, 16, v34
    v_and_b32 v43, s52, v35
    v_lshlrev_b32 v42, 16, v35
    v_pk_add_f32 v[46:47], v[36:37], v[38:39]
    v_pk_add_f32 v[44:45], v[40:41], v[42:43]
    v_pk_add_f32 v[46:47], v[46:47], v[44:45]
    v_add_f32 v46, v46, v47
    s_nop 1
    v_add_f32_dpp v46, v46, v46 row_ror:8 row_mask:0xf bank_mask:0xf
    s_nop 1
    v_add_f32_dpp v46, v46, v46 row_ror:4 row_mask:0xf bank_mask:0xf
    s_nop 1
    v_add_f32_dpp v46, v46, v46 row_ror:2 row_mask:0xf bank_mask:0xf
    s_nop 1
    v_add_f32_dpp v46, v46, v46 row_ror:1 row_mask:0xf bank_mask:0xf
    v_mov_b32 v44, v46
    s_nop 1
    v_permlane32_swap_b32 v46, v44
    v_add_f32 v46, v46, v44
    v_mov_b32 v44, v46
    s_nop 1
    v_permlane16_swap_b32 v46, v44
    v_add_f32 v46, v46, v44
    v_mul_f32 v46, 0x3b000000, v46
    v_pk_add_f32 v[36:37], v[36:37], v[46:47] op_sel_hi:[1,0] neg_lo:[0,1] neg_hi:[0,1]
    v_pk_add_f32 v[38:39], v[38:39], v[46:47] op_sel_hi:[1,0] neg_lo:[0,1] neg_hi:[0,1]
    v_pk_add_f32 v[40:41], v[40:41], v[46:47] op_sel_hi:[1,0] neg_lo:[0,1] neg_hi:[0,1]
    v_pk_add_f32 v[42:43], v[42:43], v[46:47] op_sel_hi:[1,0] neg_lo:[0,1] neg_hi:[0,1]
    v_pk_mul_f32 v[36:37], v[36:37], v[36:37]
    v_pk_fma_f32 v[36:37], v[38:39], v[38:39], v[36:37]
    v_pk_fma_f32 v[36:37], v[40:41], v[40:41], v[36:37]
    v_pk_fma_f32 v[36:37], v[42:43], v[42:43], v[36:37]
    v_add_f32 v47, v36, v37
    s_nop 1
    v_add_f32_dpp v47, v47, v47 row_ror:8 row_mask:0xf bank_mask:0xf
    s_nop 1
    v_add_f32_dpp v47, v47, v47 row_ror:4 row_mask:0xf bank_mask:0xf
    s_nop 1
    v_add_f32_dpp v47, v47, v47 row_ror:2 row_mask:0xf bank_mask:0xf
    s_nop 1
    v_add_f32_dpp v47, v47, v47 row_ror:1 row_mask:0xf bank_mask:0xf
    v_mov_b32 v44, v47
    s_nop 1
    v_permlane32_swap_b32 v47, v44
    v_add_f32 v47, v47, v44
    v_mov_b32 v44, v47
    s_nop 1
    v_permlane16_swap_b32 v47, v44
    v_add_f32 v47, v47, v44
    v_mul_f32 v47, 0x3b000000, v47
    v_cvt_pk_bf16_f32 v47, v46, v47
    v_lshlrev_b32 v46, 16, v47
    v_and_b32 v47, s52, v47
    v_add_f32 v47, 0x3727c5ac, v47
    v_cvt_pk_bf16_f32 v47, v47, v47
    v_lshlrev_b32 v47, 16, v47
    v_sqrt_f32 v47, v47
    s_nop 0
    v_cvt_pk_bf16_f32 v47, v47, v47
    v_lshlrev_b32 v47, 16, v47
    v_rcp_f32 v47, v47
    v_sub_f32 v76, v76, v46
    v_sub_f32 v77, v77, v46
    v_cvt_pk_bf16_f32 v77, v76, v77
    v_lshlrev_b32 v76, 16, v77
    v_and_b32 v77, s52, v77
    v_mul_f32 v76, v76, v47
    v_mul_f32 v77, v77, v47
    v_cvt_pk_bf16_f32 v77, v76, v77
    v_lshlrev_b32 v76, 16, v77
    v_and_b32 v77, s52, v77
    v_pk_mul_f32 v[76:77], v[76:77], v[88:89]
    v_cvt_pk_bf16_f32 v77, v76, v77
    v_lshlrev_b32 v76, 16, v77
    v_and_b32 v77, s52, v77
    v_pk_add_f32 v[76:77], v[76:77], v[86:87]
    v_cvt_pk_bf16_f32 v76, v76, v77
    s_nop 1
    v_mov_b32_dpp v72, v76 quad_perm:[0,0,0,0] row_mask:0xf bank_mask:0xf
    v_mov_b32_dpp v73, v76 quad_perm:[1,1,1,1] row_mask:0xf bank_mask:0xf
    v_mov_b32_dpp v74, v76 quad_perm:[2,2,2,2] row_mask:0xf bank_mask:0xf
    v_mov_b32_dpp v75, v76 quad_perm:[3,3,3,3] row_mask:0xf bank_mask:0xf
    v_dot2_f32_bf16 v8, v127, v72, 0
    v_dot2_f32_bf16 v9, v132, v72, 0
    v_dot2_f32_bf16 v10, v128, v72, 0
    v_dot2_f32_bf16 v11, v133, v72, 0
    v_dot2_f32_bf16 v12, v129, v72, 0
    v_dot2_f32_bf16 v13, v134, v72, 0
    v_dot2_f32_bf16 v14, v130, v72, 0
    v_dot2_f32_bf16 v15, v135, v72, 0
    v_dot2_f32_bf16 v8, v131, v73, v8
    v_dot2_f32_bf16 v9, v140, v73, v9
    v_dot2_f32_bf16 v10, v136, v73, v10
    v_dot2_f32_bf16 v11, v141, v73, v11
    v_dot2_f32_bf16 v12, v137, v73, v12
    v_dot2_f32_bf16 v13, v142, v73, v13
    v_dot2_f32_bf16 v14, v138, v73, v14
    v_dot2_f32_bf16 v15, v143, v73, v15
    v_dot2_f32_bf16 v8, v139, v74, v8
    v_dot2_f32_bf16 v9, v148, v74, v9
    v_dot2_f32_bf16 v10, v144, v74, v10
    v_dot2_f32_bf16 v11, v149, v74, v11
    v_dot2_f32_bf16 v12, v145, v74, v12
    v_dot2_f32_bf16 v13, v150, v74, v13
    v_dot2_f32_bf16 v14, v146, v74, v14
    v_dot2_f32_bf16 v15, v151, v74, v15
    v_dot2_f32_bf16 v8, v147, v75, v8
    v_dot2_f32_bf16 v9, v156, v75, v9
    v_dot2_f32_bf16 v10, v152, v75, v10
    v_dot2_f32_bf16 v11, v157, v75, v11
    v_dot2_f32_bf16 v12, v153, v75, v12
    v_dot2_f32_bf16 v13, v158, v75, v13
    v_dot2_f32_bf16 v14, v154, v75, v14
    v_dot2_f32_bf16 v15, v159, v75, v15
    v_dot2_f32_bf16 v16, v126, v72, 0
    v_dot2_f32_bf16 v17, v164, v72, 0
    v_dot2_f32_bf16 v18, v160, v72, 0
    v_dot2_f32_bf16 v19, v165, v72, 0
    v_dot2_f32_bf16 v20, v161, v72, 0
    v_dot2_f32_bf16 v21, v166, v72, 0
    v_dot2_f32_bf16 v22, v162, v72, 0
    v_dot2_f32_bf16 v23, v167, v72, 0
    v_dot2_f32_bf16 v16, v163, v73, v16
    v_dot2_f32_bf16 v17, v172, v73, v17
    v_dot2_f32_bf16 v18, v168, v73, v18
    v_dot2_f32_bf16 v19, v173, v73, v19
    v_dot2_f32_bf16 v20, v169, v73, v20
    v_dot2_f32_bf16 v21, v174, v73, v21
    v_dot2_f32_bf16 v22, v170, v73, v22
    v_dot2_f32_bf16 v23, v175, v73, v23
    v_dot2_f32_bf16 v16, v171, v74, v16
    v_dot2_f32_bf16 v17, v180, v74, v17
    v_dot2_f32_bf16 v18, v176, v74, v18
    v_dot2_f32_bf16 v19, v181, v74, v19
    v_dot2_f32_bf16 v20, v177, v74, v20
    v_dot2_f32_bf16 v21, v182, v74, v21
    v_dot2_f32_bf16 v22, v178, v74, v22
    v_dot2_f32_bf16 v23, v183, v74, v23
    v_dot2_f32_bf16 v16, v179, v75, v16
    v_dot2_f32_bf16 v17, v188, v75, v17
    v_dot2_f32_bf16 v18, v184, v75, v18
    v_dot2_f32_bf16 v19, v189, v75, v19
    v_dot2_f32_bf16 v20, v185, v75, v20
    v_dot2_f32_bf16 v21, v190, v75, v21
    v_dot2_f32_bf16 v22, v186, v75, v22
    v_dot2_f32_bf16 v23, v191, v75, v23
    v_permlane32_swap_b32 v8, v12
    v_permlane32_swap_b32 v9, v13
    v_permlane32_swap_b32 v10, v14
    v_permlane32_swap_b32 v11, v15
    v_permlane32_swap_b32 v16, v20
    v_permlane32_swap_b32 v17, v21
    v_permlane32_swap_b32 v18, v22
    v_permlane32_swap_b32 v19, v23
    v_add_f32 v8, v8, v12
    v_add_f32 v9, v9, v13
    v_add_f32 v10, v10, v14
    v_add_f32 v11, v11, v15
    v_add_f32 v16, v16, v20
    v_add_f32 v17, v17, v21
    v_add_f32 v18, v18, v22
    v_add_f32 v19, v19, v23
    v_permlane16_swap_b32 v8, v10
    v_permlane16_swap_b32 v9, v11
    v_permlane16_swap_b32 v16, v18
    v_permlane16_swap_b32 v17, v19
    v_add_f32 v8, v8, v10
    v_add_f32 v9, v9, v11
    v_add_f32 v16, v16, v18
    v_add_f32 v17, v17, v19
    v_add_f32_dpp v8, v8, v8 row_ror:8 row_mask:0xf bank_mask:0xf
    v_add_f32_dpp v9, v9, v9 row_ror:8 row_mask:0xf bank_mask:0xf
    v_add_f32_dpp v16, v16, v16 row_ror:8 row_mask:0xf bank_mask:0xf
    v_add_f32_dpp v17, v17, v17 row_ror:8 row_mask:0xf bank_mask:0xf
    v_add_f32_dpp v8, v8, v8 row_ror:4 row_mask:0xf bank_mask:0xf
    v_add_f32_dpp v9, v9, v9 row_ror:4 row_mask:0xf bank_mask:0xf
    v_add_f32_dpp v16, v16, v16 row_ror:4 row_mask:0xf bank_mask:0xf
    v_add_f32_dpp v17, v17, v17 row_ror:4 row_mask:0xf bank_mask:0xf
    ds_write_b64 v67, v[8:9] offset:512
    ds_write_b64 v67, v[16:17] offset:1024
    s_waitcnt lgkmcnt(0)
    s_cbranch_execz L_nb2
    s_barrier
L_nb2:
    ds_read2st64_b32 v[32:33], v113 offset0:2 offset1:4
    ds_read2st64_b32 v[34:35], v122 offset0:2 offset1:4
    ds_read2st64_b32 v[36:37], v113 offset0:3 offset1:5
    ds_read2st64_b32 v[38:39], v122 offset0:3 offset1:5
    s_waitcnt lgkmcnt(0)
    v_pk_add_f32 v[32:33], v[32:33], v[34:35]
    v_pk_add_f32 v[36:37], v[36:37], v[38:39]
    v_pk_add_f32 v[32:33], v[32:33], v[36:37]
    v_cvt_pk_bf16_f32 v33, v32, v33
    v_lshlrev_b32 v32, 16, v33
    v_and_b32 v33, s52, v33
    v_mul_f32 v34, v32, v32
    v_mul_f32 v34, 0x3d372713, v34
    v_fma_f32 v34, v34, v32, v32
    v_mul_f32 v34, 0xc0135761, v34
    v_exp_f32 v34, v34
    s_nop 0
    v_add_f32 v34, 1.0, v34
    v_rcp_f32 v34, v34
    s_nop 0
    v_mul_f32 v34, v34, v32
    v_cvt_pk_bf16_f32 v34, v34, v34
    v_lshlrev_b32 v34, 16, v34
    v_mul_f32 v34, v34, v33
    v_cvt_pk_bf16_f32 v34, v34, v34
    ds_write_b16 v112, v34 offset:2560
    ds_read_b128 v[72:75], v114 offset:2560
    s_waitcnt lgkmcnt(0)
    v_dot2_f32_bf16 v8, v125, v72, 0
    v_dot2_f32_bf16 v9, v196, v72, 0
    v_dot2_f32_bf16 v10, v192, v72, 0
    v_dot2_f32_bf16 v11, v197, v72, 0
    v_dot2_f32_bf16 v12, v193, v72, 0
    v_dot2_f32_bf16 v13, v198, v72, 0
    v_dot2_f32_bf16 v14, v194, v72, 0
    v_dot2_f32_bf16 v15, v199, v72, 0
    v_dot2_f32_bf16 v8, v195, v73, v8
    v_dot2_f32_bf16 v9, v204, v73, v9
    v_dot2_f32_bf16 v10, v200, v73, v10
    v_dot2_f32_bf16 v11, v205, v73, v11
    v_dot2_f32_bf16 v12, v201, v73, v12
    v_dot2_f32_bf16 v13, v206, v73, v13
    v_dot2_f32_bf16 v14, v202, v73, v14
    v_dot2_f32_bf16 v15, v207, v73, v15
    v_dot2_f32_bf16 v8, v203, v74, v8
    v_dot2_f32_bf16 v9, v212, v74, v9
    v_dot2_f32_bf16 v10, v208, v74, v10
    v_dot2_f32_bf16 v11, v213, v74, v11
    v_dot2_f32_bf16 v12, v209, v74, v12
    v_dot2_f32_bf16 v13, v214, v74, v13
    v_dot2_f32_bf16 v14, v210, v74, v14
    v_dot2_f32_bf16 v15, v215, v74, v15
    v_dot2_f32_bf16 v8, v211, v75, v8
    v_dot2_f32_bf16 v9, v220, v75, v9
    v_dot2_f32_bf16 v10, v216, v75, v10
    v_dot2_f32_bf16 v11, v221, v75, v11
    v_dot2_f32_bf16 v12, v217, v75, v12
    v_dot2_f32_bf16 v13, v222, v75, v13
    v_dot2_f32_bf16 v14, v218, v75, v14
    v_dot2_f32_bf16 v15, v223, v75, v15
    v_permlane32_swap_b32 v8, v12
    v_permlane32_swap_b32 v9, v13
    v_permlane32_swap_b32 v10, v14
    v_permlane32_swap_b32 v11, v15
    v_add_f32 v8, v8, v12
    v_add_f32 v9, v9, v13
    v_add_f32 v10, v10, v14
    v_add_f32 v11, v11, v15
    s_nop 0
    v_permlane16_swap_b32 v8, v10
    v_permlane16_swap_b32 v9, v11
    v_add_f32 v8, v8, v10
    v_add_f32 v9, v9, v11
    v_min_u32 v8, -2, v8
    v_min_u32 v9, -2, v9
    buffer_store_dwordx2 v[8:9], v115, s[36:39], s48 offen sc1
    s_cmp_ge_u32 s68, 32
    s_cbranch_scc1 L_end
    s_add_u32 s48, s90, 344064
L_poll12:
    buffer_load_dwordx4 v[32:35], v31, s[36:39], s48 offen sc1
    s_waitcnt vmcnt(0)
    v_max_u32 v24, v32, v33
    v_max3_u32 v24, v24, v34, v35
    v_cmp_eq_u32 vcc, -1, v24
    s_cbranch_vccz L_pdone13
    s_mov_b64 exec, vcc
    s_sub_u32 s59, s59, 1
    s_cbranch_scc1 L_end
    s_branch L_poll12
L_pdone13:
    s_mov_b64 exec, s[66:67]
    v_permlane32_swap_b32 v32, v34
    v_permlane32_swap_b32 v33, v35
    v_add_f32 v32, v32, v34
    v_add_f32 v33, v33, v35
    s_nop 1
    v_permlane16_swap_b32 v32, v33
    v_add_f32 v32, v32, v33
    s_nop 1
    v_add_f32_dpp v32, v32, v32 row_ror:8 row_mask:0xf bank_mask:0xf
    s_nop 1
    v_add_f32_dpp v32, v32, v32 row_ror:4 row_mask:0xf bank_mask:0xf
    s_nop 1
    v_add_f32_dpp v32, v32, v32 row_ror:2 row_mask:0xf bank_mask:0xf
    s_nop 1
    v_add_f32_dpp v32, v32, v32 row_ror:1 row_mask:0xf bank_mask:0xf
    v_cvt_pk_bf16_f32 v32, v32, v32
    v_lshlrev_b32 v32, 16, v32
    v_mul_f32 v32, v32, v108
    v_cvt_pk_bf16_f32 v32, v32, v32
    v_lshlrev_b32 v32, 16, v32
    v_lshlrev_b32 v109, 16, v109
    v_add_f32 v32, v32, v109
    v_cvt_pk_bf16_f32 v32, v32, v32
    s_and_b64 exec, s[64:65], s[66:67]
    buffer_store_short v32, v116, s[60:63], 0 offen
    s_or_b32 s35, s68, s33
    s_cbranch_scc1 L_end
    s_and_b64 exec, 1, s[66:67]
    v_mov_b32 v24, s32
    buffer_store_dword v24, off, s[36:39], 0 sc1
L_end:
L_exit:
    s_endpgm
.section .rodata,"a"
.p2align 6
.amdhsa_kernel adaLN_cond__mha_block_cached__geglu_ffn__decode_kernel
  .amdhsa_next_free_vgpr 256
  .amdhsa_next_free_sgpr 102
  .amdhsa_accum_offset 256
  .amdhsa_group_segment_fixed_size 0
  .amdhsa_kernarg_size 112
  .amdhsa_user_sgpr_count 2
  .amdhsa_user_sgpr_kernarg_segment_ptr 1
  .amdhsa_system_sgpr_workgroup_id_x 1
  .amdhsa_float_denorm_mode_32 3
.end_amdhsa_kernel
```
